```python
import torch

def _softmax(x, axis=-1):
    return torch.softmax(x, dim=axis)
def _gelu(x):
    return torch.nn.functional.gelu(x, approximate="tanh")
def _silu(x):
    return torch.nn.functional.silu(x)
def _sigmoid(x):
    return torch.sigmoid(x)
def _layernorm(x, axis=-1, eps=1e-5):
    m = x.mean(dim=axis, keepdim=True)
    v = x.var(dim=axis, keepdim=True, unbiased=False)
    return (x - m) / torch.sqrt(v + eps)
def _scatter_add(tgt, idx, src, axis=0):
    return tgt.clone().index_add_(axis, idx, src)
def _segment_sum(src, seg, n):
    out = torch.zeros((n,) + src.shape[1:], dtype=src.dtype)
    return out.index_add_(0, seg, src)
def _pad(x, pw):
    flat = tuple(v for pair in reversed(pw) for v in pair)
    return torch.nn.functional.pad(x, flat)

kernel_name = 'parallel_sum__gqa_block_cached__dense_activation_squared_relu__decode'

def setup_inputs():

    _w = (lambda a: (lambda t: t.to(torch.bfloat16) if t.is_floating_point() else t)(torch.as_tensor(a)))
    def _A_setup():
        B, Sq, D = 8, 1, 512
        Hq, Hkv, Sk, Dh = 32, 32, 4096, 128
        assert Hq % Hkv == 0, (Hq, Hkv)
        return {
            "x": _w((lambda *s: torch.randn(*s, dtype=torch.bfloat16) * 0.05)(B, Sq, D)),
            "k_cache": _w((lambda *s: torch.randn(*s, dtype=torch.bfloat16) * 1.6)(B, Hkv, Sk, Dh)),
            "v_cache": _w((lambda *s: torch.randn(*s, dtype=torch.bfloat16) * 3.2)(B, Hkv, Sk, Dh)),
            "wq": _w((lambda *s: torch.randn(*s, dtype=torch.bfloat16) * 1.6)(D, Hq * Dh) * (D ** -0.5)),
            "wo": _w((lambda *s: torch.randn(*s, dtype=torch.bfloat16) * 3.2)(Hq * Dh, D) * ((Hq * Dh) ** -0.5)),
        }
    _A_in = _A_setup()

    def _B_setup():
        B, S, D, F = 8, 1, 512, 1376
        return {
            "x": _w((lambda *s: torch.randn(*s, dtype=torch.bfloat16) * 0.05)(B, S, D)),
            "w1": _w((lambda *s: torch.randn(*s, dtype=torch.bfloat16) * 0.05)(D, F)),
            "b1": _w((lambda *s: torch.randn(*s, dtype=torch.bfloat16) * 0.4)(F)),
            "w2": _w((lambda *s: torch.randn(*s, dtype=torch.bfloat16) * 0.05)(F, D)),
            "b2": _w((lambda *s: torch.randn(*s, dtype=torch.bfloat16) * 1.6)(D)),
        }
    _B_in = _B_setup()

    return {
        "A_x": _A_in["x"],
        "A_k_cache": _A_in["k_cache"],
        "A_v_cache": _A_in["v_cache"],
        "A_wq": _A_in["wq"],
        "A_wo": _A_in["wo"],
        "B_x": _B_in["x"],
        "B_w1": _B_in["w1"],
        "B_b1": _B_in["b1"],
        "B_w2": _B_in["w2"],
        "B_b2": _B_in["b2"],
    }

def reference(A_x, A_k_cache, A_v_cache, A_wq, A_wo, B_x, B_w1, B_b1, B_w2, B_b2):
    def _A_ref(x, k_cache, v_cache, wq, wo):
        B, Sq, D = x.shape
        Hq, Dh = 32, 128
        Hkv = k_cache.shape[1]
        rep = Hq // Hkv
        q = (lambda x, *d: x.permute(*d))((x @ wq).reshape(B, Sq, Hq, Dh), 0, 2, 1, 3)
        k = (lambda x, n, axis: torch.repeat_interleave(x, n, dim=axis))(k_cache, rep, axis=1)
        v = (lambda x, n, axis: torch.repeat_interleave(x, n, dim=axis))(v_cache, rep, axis=1)
        scores = torch.einsum("bhqd,bhkd->bhqk", q, k) * (Dh ** -0.5)
        p = _softmax(scores, axis=-1)
        o = torch.einsum("bhqk,bhkd->bhqd", p, v)
        return (lambda x, *d: x.permute(*d))(o, 0, 2, 1, 3).reshape(B, Sq, Hq * Dh) @ wo

    def _B_ref(x, w1, b1, w2, b2):
        h = torch.einsum("bsd,df->bsf", x, w1) + b1
        zero = torch.zeros_like(h)
        r = torch.where(h > zero, h, zero)
        h = r * r
        out = torch.einsum("bsf,fd->bsd", h, w2) + b2
        return out

    x = A_x
    xn = _layernorm(x, axis=-1)
    return x + _A_ref(xn, A_k_cache, A_v_cache, A_wq, A_wo) + _B_ref(xn, B_w1, B_b1, B_w2, B_b2)
```

```asm
; @launch grid=(256,1,1) block=(320,1,1) lds=162176
.amdgcn_target "amdgcn-amd-amdhsa--gfx950"
.text
.globl parallel_sum__gqa_block_cached__dense_activation_squared_relu__decode_kernel
.p2align 12
.type parallel_sum__gqa_block_cached__dense_activation_squared_relu__decode_kernel,@function
parallel_sum__gqa_block_cached__dense_activation_squared_relu__decode_kernel:
s_cmp_ge_u32 s2, 256
s_cbranch_scc1 L_end
s_load_dwordx16 s[4:19], s[0:1], 0
s_load_dwordx8 s[20:27], s[0:1], 64
s_load_dwordx2 s[28:29], s[0:1], 96
v_lshrrev_b32 v1, 6, v0
v_and_b32 v0, 63, v0
v_readfirstlane_b32 s3, v1
v_lshrrev_b32 v2, 4, v0
v_and_b32 v3, 15, v0
s_and_b32 s30, s2, 31
s_lshr_b32 s31, s2, 5
s_lshl_b32 s46, s31, 5
s_add_u32 s46, s46, s30
v_mov_b32 v68, 161792
s_mov_b32 s66, 0x200000
v_mov_b32 v9, 0
v_lshl_add_u32 v8, v3, 2, v68
ds_write_b32 v8, v9
s_waitcnt lgkmcnt(0)
s_cmp_eq_u32 s3, 0
s_cbranch_scc1 L_loader
s_barrier
s_cmp_lg_u32 s3, 0
s_cbranch_scc1 L_consumer
L_loader:
s_setprio 3
v_xor_b32 v4, v3, v2
v_lshlrev_b32 v4, 4, v4
v_lshl_add_u32 v4, v2, 8, v4
v_xor_b32 v5, 64, v4
v_xor_b32 v6, 0x80, v4
v_xor_b32 v7, 0xc0, v4
v_lshlrev_b32 v8, 4, v0
s_lshl_b32 s47, s46, 20
s_mov_b32 s48, s47
s_mov_b32 m0, 0
s_mov_b32 s32, s6
s_and_b32 s33, s7, 0xffff
s_mov_b32 s34, 268435456
s_mov_b32 s35, 0x20000
s_mov_b32 s49, 0
s_mov_b32 s51, 0
buffer_load_dwordx4 v4, s[32:35], s48 offen offset:0 nt lds
buffer_load_dwordx4 v5, s[32:35], s48 offen offset:1024 nt lds
buffer_load_dwordx4 v6, s[32:35], s48 offen offset:2048 nt lds
buffer_load_dwordx4 v7, s[32:35], s48 offen offset:3072 nt lds
s_add_u32 s48, s48, 4096
s_add_u32 s50, m0, 4096
s_and_b32 m0, s50, 0x1ffff
s_add_u32 s49, s49, 1
buffer_load_dwordx4 v4, s[32:35], s48 offen offset:0 nt lds
buffer_load_dwordx4 v5, s[32:35], s48 offen offset:1024 nt lds
buffer_load_dwordx4 v6, s[32:35], s48 offen offset:2048 nt lds
buffer_load_dwordx4 v7, s[32:35], s48 offen offset:3072 nt lds
s_add_u32 s48, s48, 4096
s_add_u32 s50, m0, 4096
s_and_b32 m0, s50, 0x1ffff
s_add_u32 s49, s49, 1
buffer_load_dwordx4 v4, s[32:35], s48 offen offset:0 nt lds
buffer_load_dwordx4 v5, s[32:35], s48 offen offset:1024 nt lds
buffer_load_dwordx4 v6, s[32:35], s48 offen offset:2048 nt lds
buffer_load_dwordx4 v7, s[32:35], s48 offen offset:3072 nt lds
s_add_u32 s48, s48, 4096
s_add_u32 s50, m0, 4096
s_and_b32 m0, s50, 0x1ffff
s_add_u32 s49, s49, 1
buffer_load_dwordx4 v4, s[32:35], s48 offen offset:0 nt lds
buffer_load_dwordx4 v5, s[32:35], s48 offen offset:1024 nt lds
buffer_load_dwordx4 v6, s[32:35], s48 offen offset:2048 nt lds
buffer_load_dwordx4 v7, s[32:35], s48 offen offset:3072 nt lds
s_add_u32 s48, s48, 4096
s_add_u32 s50, m0, 4096
s_and_b32 m0, s50, 0x1ffff
s_add_u32 s49, s49, 1
s_barrier
s_mov_b32 s51, 1
ds_read_b128 v[12:15], v68 offset:16
s_branch L_fok0
L_round0:
s_sub_u32 s52, s51, 7
s_waitcnt lgkmcnt(4)
L_fchk0:
v_min_u32 v12, v12, v13
v_min3_u32 v12, v12, v14, v15
s_nop 0
v_readfirstlane_b32 s53, v12
ds_read_b128 v[12:15], v68 offset:16
s_cmp_ge_i32 s53, s52
s_cbranch_scc1 L_fok0
s_waitcnt lgkmcnt(0)
s_sub_u32 s66, s66, 1
s_cbranch_scc1 L_end
s_branch L_fchk0
L_fok0:
s_waitcnt vmcnt(19)
buffer_load_dwordx4 v4, s[32:35], s48 offen offset:0 nt lds
s_waitcnt vmcnt(19)
buffer_load_dwordx4 v5, s[32:35], s48 offen offset:1024 nt lds
s_waitcnt vmcnt(19)
buffer_load_dwordx4 v6, s[32:35], s48 offen offset:2048 nt lds
s_waitcnt vmcnt(19)
buffer_load_dwordx4 v7, s[32:35], s48 offen offset:3072 nt lds
s_sub_u32 s50, s49, 4
v_mov_b32 v9, s50
ds_write_b32 v68, v9
s_add_u32 s48, s48, 4096
s_add_u32 s50, m0, 4096
s_and_b32 m0, s50, 0x1ffff
s_add_u32 s49, s49, 1
s_waitcnt vmcnt(19)
buffer_load_dwordx4 v4, s[32:35], s48 offen offset:0 nt lds
s_waitcnt vmcnt(19)
buffer_load_dwordx4 v5, s[32:35], s48 offen offset:1024 nt lds
s_waitcnt vmcnt(19)
buffer_load_dwordx4 v6, s[32:35], s48 offen offset:2048 nt lds
s_waitcnt vmcnt(19)
buffer_load_dwordx4 v7, s[32:35], s48 offen offset:3072 nt lds
s_sub_u32 s50, s49, 4
v_mov_b32 v9, s50
ds_write_b32 v68, v9
s_add_u32 s48, s48, 4096
s_add_u32 s50, m0, 4096
s_and_b32 m0, s50, 0x1ffff
s_add_u32 s49, s49, 1
s_waitcnt vmcnt(19)
buffer_load_dwordx4 v4, s[32:35], s48 offen offset:0 nt lds
s_waitcnt vmcnt(19)
buffer_load_dwordx4 v5, s[32:35], s48 offen offset:1024 nt lds
s_waitcnt vmcnt(19)
buffer_load_dwordx4 v6, s[32:35], s48 offen offset:2048 nt lds
s_waitcnt vmcnt(19)
buffer_load_dwordx4 v7, s[32:35], s48 offen offset:3072 nt lds
s_sub_u32 s50, s49, 4
v_mov_b32 v9, s50
ds_write_b32 v68, v9
s_add_u32 s48, s48, 4096
s_add_u32 s50, m0, 4096
s_and_b32 m0, s50, 0x1ffff
s_add_u32 s49, s49, 1
s_waitcnt vmcnt(19)
buffer_load_dwordx4 v4, s[32:35], s48 offen offset:0 nt lds
s_waitcnt vmcnt(19)
buffer_load_dwordx4 v5, s[32:35], s48 offen offset:1024 nt lds
s_waitcnt vmcnt(19)
buffer_load_dwordx4 v6, s[32:35], s48 offen offset:2048 nt lds
s_waitcnt vmcnt(19)
buffer_load_dwordx4 v7, s[32:35], s48 offen offset:3072 nt lds
s_sub_u32 s50, s49, 4
v_mov_b32 v9, s50
ds_write_b32 v68, v9
s_add_u32 s48, s48, 4096
s_add_u32 s50, m0, 4096
s_and_b32 m0, s50, 0x1ffff
s_add_u32 s49, s49, 1
s_add_u32 s51, s51, 1
s_cmp_lt_u32 s51, 64
s_cbranch_scc1 L_round0
s_mov_b32 s32, s8
s_and_b32 s33, s9, 0xffff
s_mov_b32 s48, s47
v_mov_b32 v4, v8
v_mov_b32 v5, v8
v_mov_b32 v6, v8
v_mov_b32 v7, v8
L_round1:
s_sub_u32 s52, s51, 7
s_waitcnt lgkmcnt(4)
L_fchk1:
v_min_u32 v12, v12, v13
v_min3_u32 v12, v12, v14, v15
s_nop 0
v_readfirstlane_b32 s53, v12
ds_read_b128 v[12:15], v68 offset:16
s_cmp_ge_i32 s53, s52
s_cbranch_scc1 L_fok1
s_waitcnt lgkmcnt(0)
s_sub_u32 s66, s66, 1
s_cbranch_scc1 L_end
s_branch L_fchk1
L_fok1:
s_waitcnt vmcnt(19)
buffer_load_dwordx4 v4, s[32:35], s48 offen offset:0 nt lds
s_waitcnt vmcnt(19)
buffer_load_dwordx4 v5, s[32:35], s48 offen offset:1024 nt lds
s_waitcnt vmcnt(19)
buffer_load_dwordx4 v6, s[32:35], s48 offen offset:2048 nt lds
s_waitcnt vmcnt(19)
buffer_load_dwordx4 v7, s[32:35], s48 offen offset:3072 nt lds
s_sub_u32 s50, s49, 4
v_mov_b32 v9, s50
ds_write_b32 v68, v9
s_add_u32 s48, s48, 4096
s_add_u32 s50, m0, 4096
s_and_b32 m0, s50, 0x1ffff
s_add_u32 s49, s49, 1
s_waitcnt vmcnt(19)
buffer_load_dwordx4 v4, s[32:35], s48 offen offset:0 nt lds
s_waitcnt vmcnt(19)
buffer_load_dwordx4 v5, s[32:35], s48 offen offset:1024 nt lds
s_waitcnt vmcnt(19)
buffer_load_dwordx4 v6, s[32:35], s48 offen offset:2048 nt lds
s_waitcnt vmcnt(19)
buffer_load_dwordx4 v7, s[32:35], s48 offen offset:3072 nt lds
s_sub_u32 s50, s49, 4
v_mov_b32 v9, s50
ds_write_b32 v68, v9
s_add_u32 s48, s48, 4096
s_add_u32 s50, m0, 4096
s_and_b32 m0, s50, 0x1ffff
s_add_u32 s49, s49, 1
s_waitcnt vmcnt(19)
buffer_load_dwordx4 v4, s[32:35], s48 offen offset:0 nt lds
s_waitcnt vmcnt(19)
buffer_load_dwordx4 v5, s[32:35], s48 offen offset:1024 nt lds
s_waitcnt vmcnt(19)
buffer_load_dwordx4 v6, s[32:35], s48 offen offset:2048 nt lds
s_waitcnt vmcnt(19)
buffer_load_dwordx4 v7, s[32:35], s48 offen offset:3072 nt lds
s_sub_u32 s50, s49, 4
v_mov_b32 v9, s50
ds_write_b32 v68, v9
s_add_u32 s48, s48, 4096
s_add_u32 s50, m0, 4096
s_and_b32 m0, s50, 0x1ffff
s_add_u32 s49, s49, 1
s_waitcnt vmcnt(19)
buffer_load_dwordx4 v4, s[32:35], s48 offen offset:0 nt lds
s_waitcnt vmcnt(19)
buffer_load_dwordx4 v5, s[32:35], s48 offen offset:1024 nt lds
s_waitcnt vmcnt(19)
buffer_load_dwordx4 v6, s[32:35], s48 offen offset:2048 nt lds
s_waitcnt vmcnt(19)
buffer_load_dwordx4 v7, s[32:35], s48 offen offset:3072 nt lds
s_sub_u32 s50, s49, 4
v_mov_b32 v9, s50
ds_write_b32 v68, v9
s_add_u32 s48, s48, 4096
s_add_u32 s50, m0, 4096
s_and_b32 m0, s50, 0x1ffff
s_add_u32 s49, s49, 1
s_add_u32 s51, s51, 1
s_cmp_lt_u32 s51, 128
s_cbranch_scc1 L_round1
s_waitcnt vmcnt(16)
v_mov_b32 v9, 508
ds_write_b32 v68, v9
s_waitcnt vmcnt(12)
v_mov_b32 v9, 509
ds_write_b32 v68, v9
s_waitcnt vmcnt(8)
v_mov_b32 v9, 510
ds_write_b32 v68, v9
s_waitcnt vmcnt(4)
v_mov_b32 v9, 511
ds_write_b32 v68, v9
s_waitcnt vmcnt(0)
v_mov_b32 v9, 512
ds_write_b32 v68, v9
s_endpgm
L_gemv:
s_nop 1
v_and_b32_dpp v16, v8, v4 row_newbcast:0 row_mask:0xf bank_mask:0xf
v_and_b32_dpp v17, v8, v5 row_newbcast:0 row_mask:0xf bank_mask:0xf
v_and_b32_dpp v18, v8, v6 row_newbcast:0 row_mask:0xf bank_mask:0xf
v_and_b32_dpp v19, v8, v7 row_newbcast:0 row_mask:0xf bank_mask:0xf
v_and_b32_dpp v20, v8, v4 row_newbcast:1 row_mask:0xf bank_mask:0xf
v_and_b32_dpp v21, v8, v5 row_newbcast:1 row_mask:0xf bank_mask:0xf
v_and_b32_dpp v22, v8, v6 row_newbcast:1 row_mask:0xf bank_mask:0xf
v_and_b32_dpp v23, v8, v7 row_newbcast:1 row_mask:0xf bank_mask:0xf
v_mfma_f32_16x16x32_bf16 v[12:15], v[128:131], v[16:19], 0
v_and_b32_dpp v16, v8, v4 row_newbcast:2 row_mask:0xf bank_mask:0xf
v_and_b32_dpp v17, v8, v5 row_newbcast:2 row_mask:0xf bank_mask:0xf
v_and_b32_dpp v18, v8, v6 row_newbcast:2 row_mask:0xf bank_mask:0xf
v_and_b32_dpp v19, v8, v7 row_newbcast:2 row_mask:0xf bank_mask:0xf
v_mfma_f32_16x16x32_bf16 v[12:15], v[132:135], v[20:23], v[12:15]
v_and_b32_dpp v20, v8, v4 row_newbcast:3 row_mask:0xf bank_mask:0xf
v_and_b32_dpp v21, v8, v5 row_newbcast:3 row_mask:0xf bank_mask:0xf
v_and_b32_dpp v22, v8, v6 row_newbcast:3 row_mask:0xf bank_mask:0xf
v_and_b32_dpp v23, v8, v7 row_newbcast:3 row_mask:0xf bank_mask:0xf
v_mfma_f32_16x16x32_bf16 v[12:15], v[136:139], v[16:19], v[12:15]
v_and_b32_dpp v16, v8, v4 row_newbcast:4 row_mask:0xf bank_mask:0xf
v_and_b32_dpp v17, v8, v5 row_newbcast:4 row_mask:0xf bank_mask:0xf
v_and_b32_dpp v18, v8, v6 row_newbcast:4 row_mask:0xf bank_mask:0xf
v_and_b32_dpp v19, v8, v7 row_newbcast:4 row_mask:0xf bank_mask:0xf
v_mfma_f32_16x16x32_bf16 v[12:15], v[140:143], v[20:23], v[12:15]
v_and_b32_dpp v20, v8, v4 row_newbcast:5 row_mask:0xf bank_mask:0xf
v_and_b32_dpp v21, v8, v5 row_newbcast:5 row_mask:0xf bank_mask:0xf
v_and_b32_dpp v22, v8, v6 row_newbcast:5 row_mask:0xf bank_mask:0xf
v_and_b32_dpp v23, v8, v7 row_newbcast:5 row_mask:0xf bank_mask:0xf
v_mfma_f32_16x16x32_bf16 v[12:15], v[144:147], v[16:19], v[12:15]
v_and_b32_dpp v16, v8, v4 row_newbcast:6 row_mask:0xf bank_mask:0xf
v_and_b32_dpp v17, v8, v5 row_newbcast:6 row_mask:0xf bank_mask:0xf
v_and_b32_dpp v18, v8, v6 row_newbcast:6 row_mask:0xf bank_mask:0xf
v_and_b32_dpp v19, v8, v7 row_newbcast:6 row_mask:0xf bank_mask:0xf
v_mfma_f32_16x16x32_bf16 v[12:15], v[148:151], v[20:23], v[12:15]
v_and_b32_dpp v20, v8, v4 row_newbcast:7 row_mask:0xf bank_mask:0xf
v_and_b32_dpp v21, v8, v5 row_newbcast:7 row_mask:0xf bank_mask:0xf
v_and_b32_dpp v22, v8, v6 row_newbcast:7 row_mask:0xf bank_mask:0xf
v_and_b32_dpp v23, v8, v7 row_newbcast:7 row_mask:0xf bank_mask:0xf
v_mfma_f32_16x16x32_bf16 v[12:15], v[152:155], v[16:19], v[12:15]
v_and_b32_dpp v16, v8, v4 row_newbcast:8 row_mask:0xf bank_mask:0xf
v_and_b32_dpp v17, v8, v5 row_newbcast:8 row_mask:0xf bank_mask:0xf
v_and_b32_dpp v18, v8, v6 row_newbcast:8 row_mask:0xf bank_mask:0xf
v_and_b32_dpp v19, v8, v7 row_newbcast:8 row_mask:0xf bank_mask:0xf
v_mfma_f32_16x16x32_bf16 v[12:15], v[156:159], v[20:23], v[12:15]
v_and_b32_dpp v20, v8, v4 row_newbcast:9 row_mask:0xf bank_mask:0xf
v_and_b32_dpp v21, v8, v5 row_newbcast:9 row_mask:0xf bank_mask:0xf
v_and_b32_dpp v22, v8, v6 row_newbcast:9 row_mask:0xf bank_mask:0xf
v_and_b32_dpp v23, v8, v7 row_newbcast:9 row_mask:0xf bank_mask:0xf
v_mfma_f32_16x16x32_bf16 v[12:15], v[160:163], v[16:19], v[12:15]
v_and_b32_dpp v16, v8, v4 row_newbcast:10 row_mask:0xf bank_mask:0xf
v_and_b32_dpp v17, v8, v5 row_newbcast:10 row_mask:0xf bank_mask:0xf
v_and_b32_dpp v18, v8, v6 row_newbcast:10 row_mask:0xf bank_mask:0xf
v_and_b32_dpp v19, v8, v7 row_newbcast:10 row_mask:0xf bank_mask:0xf
v_mfma_f32_16x16x32_bf16 v[12:15], v[164:167], v[20:23], v[12:15]
v_and_b32_dpp v20, v8, v4 row_newbcast:11 row_mask:0xf bank_mask:0xf
v_and_b32_dpp v21, v8, v5 row_newbcast:11 row_mask:0xf bank_mask:0xf
v_and_b32_dpp v22, v8, v6 row_newbcast:11 row_mask:0xf bank_mask:0xf
v_and_b32_dpp v23, v8, v7 row_newbcast:11 row_mask:0xf bank_mask:0xf
v_mfma_f32_16x16x32_bf16 v[12:15], v[168:171], v[16:19], v[12:15]
v_and_b32_dpp v16, v8, v4 row_newbcast:12 row_mask:0xf bank_mask:0xf
v_and_b32_dpp v17, v8, v5 row_newbcast:12 row_mask:0xf bank_mask:0xf
v_and_b32_dpp v18, v8, v6 row_newbcast:12 row_mask:0xf bank_mask:0xf
v_and_b32_dpp v19, v8, v7 row_newbcast:12 row_mask:0xf bank_mask:0xf
v_mfma_f32_16x16x32_bf16 v[12:15], v[172:175], v[20:23], v[12:15]
v_and_b32_dpp v20, v8, v4 row_newbcast:13 row_mask:0xf bank_mask:0xf
v_and_b32_dpp v21, v8, v5 row_newbcast:13 row_mask:0xf bank_mask:0xf
v_and_b32_dpp v22, v8, v6 row_newbcast:13 row_mask:0xf bank_mask:0xf
v_and_b32_dpp v23, v8, v7 row_newbcast:13 row_mask:0xf bank_mask:0xf
v_mfma_f32_16x16x32_bf16 v[12:15], v[176:179], v[16:19], v[12:15]
v_and_b32_dpp v16, v8, v4 row_newbcast:14 row_mask:0xf bank_mask:0xf
v_and_b32_dpp v17, v8, v5 row_newbcast:14 row_mask:0xf bank_mask:0xf
v_and_b32_dpp v18, v8, v6 row_newbcast:14 row_mask:0xf bank_mask:0xf
v_and_b32_dpp v19, v8, v7 row_newbcast:14 row_mask:0xf bank_mask:0xf
v_mfma_f32_16x16x32_bf16 v[12:15], v[180:183], v[20:23], v[12:15]
v_and_b32_dpp v20, v8, v4 row_newbcast:15 row_mask:0xf bank_mask:0xf
v_and_b32_dpp v21, v8, v5 row_newbcast:15 row_mask:0xf bank_mask:0xf
v_and_b32_dpp v22, v8, v6 row_newbcast:15 row_mask:0xf bank_mask:0xf
v_and_b32_dpp v23, v8, v7 row_newbcast:15 row_mask:0xf bank_mask:0xf
v_mfma_f32_16x16x32_bf16 v[12:15], v[184:187], v[16:19], v[12:15]
v_and_b32_dpp v16, v9, v4 row_newbcast:0 row_mask:0xf bank_mask:0xf
v_and_b32_dpp v17, v9, v5 row_newbcast:0 row_mask:0xf bank_mask:0xf
v_and_b32_dpp v18, v9, v6 row_newbcast:0 row_mask:0xf bank_mask:0xf
v_and_b32_dpp v19, v9, v7 row_newbcast:0 row_mask:0xf bank_mask:0xf
v_mfma_f32_16x16x32_bf16 v[12:15], v[188:191], v[20:23], v[12:15]
v_and_b32_dpp v20, v9, v4 row_newbcast:1 row_mask:0xf bank_mask:0xf
v_and_b32_dpp v21, v9, v5 row_newbcast:1 row_mask:0xf bank_mask:0xf
v_and_b32_dpp v22, v9, v6 row_newbcast:1 row_mask:0xf bank_mask:0xf
v_and_b32_dpp v23, v9, v7 row_newbcast:1 row_mask:0xf bank_mask:0xf
v_mfma_f32_16x16x32_bf16 v[12:15], v[192:195], v[16:19], v[12:15]
v_and_b32_dpp v16, v9, v4 row_newbcast:2 row_mask:0xf bank_mask:0xf
v_and_b32_dpp v17, v9, v5 row_newbcast:2 row_mask:0xf bank_mask:0xf
v_and_b32_dpp v18, v9, v6 row_newbcast:2 row_mask:0xf bank_mask:0xf
v_and_b32_dpp v19, v9, v7 row_newbcast:2 row_mask:0xf bank_mask:0xf
v_mfma_f32_16x16x32_bf16 v[12:15], v[196:199], v[20:23], v[12:15]
v_and_b32_dpp v20, v9, v4 row_newbcast:3 row_mask:0xf bank_mask:0xf
v_and_b32_dpp v21, v9, v5 row_newbcast:3 row_mask:0xf bank_mask:0xf
v_and_b32_dpp v22, v9, v6 row_newbcast:3 row_mask:0xf bank_mask:0xf
v_and_b32_dpp v23, v9, v7 row_newbcast:3 row_mask:0xf bank_mask:0xf
v_mfma_f32_16x16x32_bf16 v[12:15], v[200:203], v[16:19], v[12:15]
v_and_b32_dpp v16, v9, v4 row_newbcast:4 row_mask:0xf bank_mask:0xf
v_and_b32_dpp v17, v9, v5 row_newbcast:4 row_mask:0xf bank_mask:0xf
v_and_b32_dpp v18, v9, v6 row_newbcast:4 row_mask:0xf bank_mask:0xf
v_and_b32_dpp v19, v9, v7 row_newbcast:4 row_mask:0xf bank_mask:0xf
v_mfma_f32_16x16x32_bf16 v[12:15], v[204:207], v[20:23], v[12:15]
v_and_b32_dpp v20, v9, v4 row_newbcast:5 row_mask:0xf bank_mask:0xf
v_and_b32_dpp v21, v9, v5 row_newbcast:5 row_mask:0xf bank_mask:0xf
v_and_b32_dpp v22, v9, v6 row_newbcast:5 row_mask:0xf bank_mask:0xf
v_and_b32_dpp v23, v9, v7 row_newbcast:5 row_mask:0xf bank_mask:0xf
v_mfma_f32_16x16x32_bf16 v[12:15], v[208:211], v[16:19], v[12:15]
v_and_b32_dpp v16, v9, v4 row_newbcast:6 row_mask:0xf bank_mask:0xf
v_and_b32_dpp v17, v9, v5 row_newbcast:6 row_mask:0xf bank_mask:0xf
v_and_b32_dpp v18, v9, v6 row_newbcast:6 row_mask:0xf bank_mask:0xf
v_and_b32_dpp v19, v9, v7 row_newbcast:6 row_mask:0xf bank_mask:0xf
v_mfma_f32_16x16x32_bf16 v[12:15], v[212:215], v[20:23], v[12:15]
v_and_b32_dpp v20, v9, v4 row_newbcast:7 row_mask:0xf bank_mask:0xf
v_and_b32_dpp v21, v9, v5 row_newbcast:7 row_mask:0xf bank_mask:0xf
v_and_b32_dpp v22, v9, v6 row_newbcast:7 row_mask:0xf bank_mask:0xf
v_and_b32_dpp v23, v9, v7 row_newbcast:7 row_mask:0xf bank_mask:0xf
v_mfma_f32_16x16x32_bf16 v[12:15], v[216:219], v[16:19], v[12:15]
v_and_b32_dpp v16, v9, v4 row_newbcast:8 row_mask:0xf bank_mask:0xf
v_and_b32_dpp v17, v9, v5 row_newbcast:8 row_mask:0xf bank_mask:0xf
v_and_b32_dpp v18, v9, v6 row_newbcast:8 row_mask:0xf bank_mask:0xf
v_and_b32_dpp v19, v9, v7 row_newbcast:8 row_mask:0xf bank_mask:0xf
v_mfma_f32_16x16x32_bf16 v[12:15], v[220:223], v[20:23], v[12:15]
v_and_b32_dpp v20, v9, v4 row_newbcast:9 row_mask:0xf bank_mask:0xf
v_and_b32_dpp v21, v9, v5 row_newbcast:9 row_mask:0xf bank_mask:0xf
v_and_b32_dpp v22, v9, v6 row_newbcast:9 row_mask:0xf bank_mask:0xf
v_and_b32_dpp v23, v9, v7 row_newbcast:9 row_mask:0xf bank_mask:0xf
v_mfma_f32_16x16x32_bf16 v[12:15], v[224:227], v[16:19], v[12:15]
v_and_b32_dpp v16, v9, v4 row_newbcast:10 row_mask:0xf bank_mask:0xf
v_and_b32_dpp v17, v9, v5 row_newbcast:10 row_mask:0xf bank_mask:0xf
v_and_b32_dpp v18, v9, v6 row_newbcast:10 row_mask:0xf bank_mask:0xf
v_and_b32_dpp v19, v9, v7 row_newbcast:10 row_mask:0xf bank_mask:0xf
v_mfma_f32_16x16x32_bf16 v[12:15], v[228:231], v[20:23], v[12:15]
v_and_b32_dpp v20, v9, v4 row_newbcast:11 row_mask:0xf bank_mask:0xf
v_and_b32_dpp v21, v9, v5 row_newbcast:11 row_mask:0xf bank_mask:0xf
v_and_b32_dpp v22, v9, v6 row_newbcast:11 row_mask:0xf bank_mask:0xf
v_and_b32_dpp v23, v9, v7 row_newbcast:11 row_mask:0xf bank_mask:0xf
v_mfma_f32_16x16x32_bf16 v[12:15], v[232:235], v[16:19], v[12:15]
v_and_b32_dpp v16, v9, v4 row_newbcast:12 row_mask:0xf bank_mask:0xf
v_and_b32_dpp v17, v9, v5 row_newbcast:12 row_mask:0xf bank_mask:0xf
v_and_b32_dpp v18, v9, v6 row_newbcast:12 row_mask:0xf bank_mask:0xf
v_and_b32_dpp v19, v9, v7 row_newbcast:12 row_mask:0xf bank_mask:0xf
v_mfma_f32_16x16x32_bf16 v[12:15], v[236:239], v[20:23], v[12:15]
v_and_b32_dpp v20, v9, v4 row_newbcast:13 row_mask:0xf bank_mask:0xf
v_and_b32_dpp v21, v9, v5 row_newbcast:13 row_mask:0xf bank_mask:0xf
v_and_b32_dpp v22, v9, v6 row_newbcast:13 row_mask:0xf bank_mask:0xf
v_and_b32_dpp v23, v9, v7 row_newbcast:13 row_mask:0xf bank_mask:0xf
v_mfma_f32_16x16x32_bf16 v[12:15], v[240:243], v[16:19], v[12:15]
v_and_b32_dpp v16, v9, v4 row_newbcast:14 row_mask:0xf bank_mask:0xf
v_and_b32_dpp v17, v9, v5 row_newbcast:14 row_mask:0xf bank_mask:0xf
v_and_b32_dpp v18, v9, v6 row_newbcast:14 row_mask:0xf bank_mask:0xf
v_and_b32_dpp v19, v9, v7 row_newbcast:14 row_mask:0xf bank_mask:0xf
v_mfma_f32_16x16x32_bf16 v[12:15], v[244:247], v[20:23], v[12:15]
v_and_b32_dpp v20, v9, v4 row_newbcast:15 row_mask:0xf bank_mask:0xf
v_and_b32_dpp v21, v9, v5 row_newbcast:15 row_mask:0xf bank_mask:0xf
v_and_b32_dpp v22, v9, v6 row_newbcast:15 row_mask:0xf bank_mask:0xf
v_and_b32_dpp v23, v9, v7 row_newbcast:15 row_mask:0xf bank_mask:0xf
v_mfma_f32_16x16x32_bf16 v[12:15], v[248:251], v[16:19], v[12:15]
s_nop 1
v_mfma_f32_16x16x32_bf16 v[12:15], v[252:255], v[20:23], v[12:15]
s_nop 7
s_setpc_b64 s[44:45]
L_ktile:
s_cmp_ge_i32 s56, s57
s_cbranch_scc1 L_rg_2
L_rp_1:
ds_read_b32 v76, v68
s_sub_u32 s66, s66, 1
s_cbranch_scc1 L_end
s_waitcnt lgkmcnt(0)
v_readfirstlane_b32 s56, v76
s_cmp_ge_i32 s56, s57
s_cbranch_scc0 L_rp_1
L_rg_2:
v_add_u32 v76, s61, v64
v_xor_b32 v77, 64, v76
v_xor_b32 v78, 0x80, v76
v_xor_b32 v79, 0xc0, v76
ds_read_b128 v[40:43], v76
ds_read_b128 v[44:47], v77
ds_read_b128 v[48:51], v78
ds_read_b128 v[52:55], v79
s_waitcnt lgkmcnt(3)
v_mfma_f32_16x16x32_bf16 v[12:15], v[40:43], v[24:27], 0
s_waitcnt lgkmcnt(2)
v_mfma_f32_16x16x32_bf16 v[12:15], v[44:47], v[28:31], v[12:15]
s_waitcnt lgkmcnt(1)
v_mfma_f32_16x16x32_bf16 v[12:15], v[48:51], v[32:35], v[12:15]
s_waitcnt lgkmcnt(0)
v_mfma_f32_16x16x32_bf16 v[12:15], v[52:55], v[36:39], v[12:15]
v_mov_b32 v76, s62
ds_write_b32 v69, v76
s_add_u32 s61, s61, 16384
s_and_b32 s61, s61, 0x1ffff
s_add_u32 s57, s57, 4
s_add_u32 s62, s62, 1
s_nop 3
v_cvt_pk_bf16_f32 v56, v12, v13
v_cvt_pk_bf16_f32 v57, v14, v15
v_lshlrev_b32 v58, 16, v56
v_and_b32 v59, 0xffff0000, v56
v_lshlrev_b32 v60, 16, v57
v_and_b32 v61, 0xffff0000, v57
v_mul_f32 v58, 1035273459, v58
v_mul_f32 v59, 1035273459, v59
v_mul_f32 v60, 1035273459, v60
v_mul_f32 v61, 1035273459, v61
v_cvt_pk_bf16_f32 v56, v58, v59
v_cvt_pk_bf16_f32 v57, v60, v61
s_mov_b64 exec, s[64:65]
ds_write_b64 v67, v[56:57]
s_mov_b64 exec, -1
v_add_u32 v67, 32, v67
s_setpc_b64 s[44:45]
L_vtile:
s_cmp_ge_i32 s56, s57
s_cbranch_scc1 L_rg_4
L_rp_3:
ds_read_b32 v76, v68
s_sub_u32 s66, s66, 1
s_cbranch_scc1 L_end
s_waitcnt lgkmcnt(0)
v_readfirstlane_b32 s56, v76
s_cmp_ge_i32 s56, s57
s_cbranch_scc0 L_rp_3
L_rg_4:
v_add_u32 v76, s61, v65
ds_read_b128 v[56:59], v66
ds_read_b128 v[40:43], v76 offset:0
ds_read_b128 v[44:47], v76 offset:256
ds_read_b128 v[48:51], v76 offset:512
ds_read_b128 v[52:55], v76 offset:768
v_add_u32 v66, 64, v66
s_add_u32 s61, s61, 16384
s_and_b32 s61, s61, 0x1ffff
s_add_u32 s57, s57, 4
s_waitcnt lgkmcnt(4)
v_and_b32 v16, v56, v4
v_and_b32 v17, v56, v5
v_and_b32 v18, v56, v6
v_and_b32 v19, v56, v7
v_and_b32 v20, v57, v4
v_and_b32 v21, v57, v5
v_and_b32 v22, v57, v6
v_and_b32 v23, v57, v7
s_waitcnt lgkmcnt(3)
v_mfma_f32_16x16x32_bf16 v[60:63], v[40:43], v[16:19], v[60:63]
v_and_b32 v16, v58, v4
v_and_b32 v17, v58, v5
v_and_b32 v18, v58, v6
v_and_b32 v19, v58, v7
s_waitcnt lgkmcnt(2)
v_mfma_f32_16x16x32_bf16 v[60:63], v[44:47], v[20:23], v[60:63]
v_and_b32 v20, v59, v4
v_and_b32 v21, v59, v5
v_and_b32 v22, v59, v6
v_and_b32 v23, v59, v7
s_waitcnt lgkmcnt(1)
v_mfma_f32_16x16x32_bf16 v[60:63], v[48:51], v[16:19], v[60:63]
v_mov_b32 v76, s62
s_waitcnt lgkmcnt(0)
v_mfma_f32_16x16x32_bf16 v[60:63], v[52:55], v[20:23], v[60:63]
ds_write_b32 v69, v76
s_add_u32 s62, s62, 1
s_setpc_b64 s[44:45]
L_consumer:
s_sub_u32 s47, s3, 1
s_mov_b32 s54, 0x00ff00ff
s_mov_b32 s55, 0x00ff00ff
v_and_b32 v76, 1, v3
v_lshlrev_b32 v76, 4, v76
v_mov_b32 v77, 0xffff
v_lshlrev_b32 v76, v76, v77
v_lshrrev_b32 v77, 1, v3
v_cmp_eq_u32 vcc, 0, v77
s_nop 1
v_cndmask_b32 v4, 0, v76, vcc
v_cmp_eq_u32 vcc, 1, v77
s_nop 1
v_cndmask_b32 v5, 0, v76, vcc
v_cmp_eq_u32 vcc, 2, v77
s_nop 1
v_cndmask_b32 v6, 0, v76, vcc
v_cmp_eq_u32 vcc, 3, v77
s_nop 1
v_cndmask_b32 v7, 0, v76, vcc
v_lshrrev_b32 v76, 2, v3
v_lshlrev_b32 v76, 4, v76
v_lshl_add_u32 v76, v2, 2, v76
v_and_b32 v77, 3, v3
v_add_u32 v10, v76, v77
v_lshl_add_u32 v11, v10, 2, v68
v_subrev_u32 v11, 6144, v11
s_lshl_b32 s48, s31, 10
v_lshlrev_b32 v76, 4, v0
s_lshl_b32 s49, s47, 8
s_mov_b32 s50, 0
v_add_u32 v77, s50, v10
v_add_u32 v78, 64, v77
v_and_b32 v77, 127, v77
v_and_b32 v78, 127, v78
v_lshl_add_u32 v77, v77, 1, s49
v_lshl_add_u32 v78, v78, 1, s49
s_mov_b32 s40, s4
s_and_b32 s41, s5, 0xffff
s_mov_b32 s42, 8192
s_mov_b32 s43, 0x20000
buffer_load_dwordx4 v[40:43], v76, s[40:43], s48 offen
buffer_load_ushort v8, v77, s[40:43], s48 offen
buffer_load_ushort v9, v78, s[40:43], s48 offen
s_mov_b32 s32, s10
s_and_b32 s33, s11, 0xffff
s_mov_b32 s34, 4194304
s_mov_b32 s35, 0x20000
v_lshlrev_b32 v71, 15, v2
v_lshl_add_u32 v71, v3, 4, v71
s_lshl_b32 s74, s47, 20
s_lshl_b32 s49, s30, 8
s_add_u32 s74, s74, s49
s_mul_i32 s75, s50, 8192
s_add_u32 s48, s74, s75
buffer_load_dwordx4 v[128:131], v71, s[32:35], s48 offen
s_add_u32 s48, s48, 8192
buffer_load_dwordx4 v[132:135], v71, s[32:35], s48 offen
s_add_u32 s48, s48, 8192
buffer_load_dwordx4 v[136:139], v71, s[32:35], s48 offen
s_add_u32 s48, s48, 8192
buffer_load_dwordx4 v[140:143], v71, s[32:35], s48 offen
s_add_u32 s75, s75, 131072
s_cmp_eq_u32 s75, 1048576
s_cselect_b32 s75, 0, s75
s_add_u32 s48, s74, s75
buffer_load_dwordx4 v[144:147], v71, s[32:35], s48 offen
s_add_u32 s48, s48, 8192
buffer_load_dwordx4 v[148:151], v71, s[32:35], s48 offen
s_add_u32 s48, s48, 8192
buffer_load_dwordx4 v[152:155], v71, s[32:35], s48 offen
s_add_u32 s48, s48, 8192
buffer_load_dwordx4 v[156:159], v71, s[32:35], s48 offen
s_add_u32 s75, s75, 131072
s_cmp_eq_u32 s75, 1048576
s_cselect_b32 s75, 0, s75
s_add_u32 s48, s74, s75
buffer_load_dwordx4 v[160:163], v71, s[32:35], s48 offen
s_add_u32 s48, s48, 8192
buffer_load_dwordx4 v[164:167], v71, s[32:35], s48 offen
s_add_u32 s48, s48, 8192
buffer_load_dwordx4 v[168:171], v71, s[32:35], s48 offen
s_add_u32 s48, s48, 8192
buffer_load_dwordx4 v[172:175], v71, s[32:35], s48 offen
s_add_u32 s75, s75, 131072
s_cmp_eq_u32 s75, 1048576
s_cselect_b32 s75, 0, s75
s_add_u32 s48, s74, s75
buffer_load_dwordx4 v[176:179], v71, s[32:35], s48 offen
s_add_u32 s48, s48, 8192
buffer_load_dwordx4 v[180:183], v71, s[32:35], s48 offen
s_add_u32 s48, s48, 8192
buffer_load_dwordx4 v[184:187], v71, s[32:35], s48 offen
s_add_u32 s48, s48, 8192
buffer_load_dwordx4 v[188:191], v71, s[32:35], s48 offen
s_add_u32 s75, s75, 131072
s_cmp_eq_u32 s75, 1048576
s_cselect_b32 s75, 0, s75
s_add_u32 s48, s74, s75
buffer_load_dwordx4 v[192:195], v71, s[32:35], s48 offen
s_add_u32 s48, s48, 8192
buffer_load_dwordx4 v[196:199], v71, s[32:35], s48 offen
s_add_u32 s48, s48, 8192
buffer_load_dwordx4 v[200:203], v71, s[32:35], s48 offen
s_add_u32 s48, s48, 8192
buffer_load_dwordx4 v[204:207], v71, s[32:35], s48 offen
s_add_u32 s75, s75, 131072
s_cmp_eq_u32 s75, 1048576
s_cselect_b32 s75, 0, s75
s_add_u32 s48, s74, s75
buffer_load_dwordx4 v[208:211], v71, s[32:35], s48 offen
s_add_u32 s48, s48, 8192
buffer_load_dwordx4 v[212:215], v71, s[32:35], s48 offen
s_add_u32 s48, s48, 8192
buffer_load_dwordx4 v[216:219], v71, s[32:35], s48 offen
s_add_u32 s48, s48, 8192
buffer_load_dwordx4 v[220:223], v71, s[32:35], s48 offen
s_add_u32 s75, s75, 131072
s_cmp_eq_u32 s75, 1048576
s_cselect_b32 s75, 0, s75
s_add_u32 s48, s74, s75
buffer_load_dwordx4 v[224:227], v71, s[32:35], s48 offen
s_add_u32 s48, s48, 8192
buffer_load_dwordx4 v[228:231], v71, s[32:35], s48 offen
s_add_u32 s48, s48, 8192
buffer_load_dwordx4 v[232:235], v71, s[32:35], s48 offen
s_add_u32 s48, s48, 8192
buffer_load_dwordx4 v[236:239], v71, s[32:35], s48 offen
s_add_u32 s75, s75, 131072
s_cmp_eq_u32 s75, 1048576
s_cselect_b32 s75, 0, s75
s_add_u32 s48, s74, s75
buffer_load_dwordx4 v[240:243], v71, s[32:35], s48 offen
s_add_u32 s48, s48, 8192
buffer_load_dwordx4 v[244:247], v71, s[32:35], s48 offen
s_add_u32 s48, s48, 8192
buffer_load_dwordx4 v[248:251], v71, s[32:35], s48 offen
s_add_u32 s48, s48, 8192
buffer_load_dwordx4 v[252:255], v71, s[32:35], s48 offen
s_add_u32 s75, s75, 131072
s_cmp_eq_u32 s75, 1048576
s_cselect_b32 s75, 0, s75
s_mov_b32 s36, s28
s_and_b32 s37, s29, 0xffff
s_mov_b32 s38, 1073741824
s_mov_b32 s39, 0x20000
s_lshl_b32 s58, s46, 2
s_add_u32 s58, s58, s47
s_lshl_b32 s58, s58, 11
s_or_b32 s49, s2, s47
s_cmp_lg_u32 s49, 0
s_cbranch_scc1 L_skip_5
s_memrealtime s[76:77]
s_mov_b32 s40, s26
s_and_b32 s41, s27, 0xffff
s_mov_b32 s42, 256
s_mov_b32 s43, 0x20000
v_mov_b32 v78, 0
v_mov_b32 v102, 0
v_mov_b32 v103, 0
s_waitcnt lgkmcnt(0)
s_or_b32 s76, s76, 1
s_or_b32 s77, s77, 0x80000000
v_mov_b32 v100, s76
v_mov_b32 v101, s77
s_mov_b64 exec, 1
buffer_atomic_cmpswap_x2 v[100:103], v78, s[40:43], 0 offen sc1
s_mov_b64 exec, -1
L_skip_5:
s_lshl_b32 s49, s47, 2
s_add_u32 s49, s49, 16
v_add_u32 v69, s49, v68
s_lshl_b32 s49, s47, 9
s_add_u32 s49, s49, 155648
v_lshlrev_b32 v70, 7, v2
v_lshl_add_u32 v70, v3, 2, v70
v_add_u32 v70, s49, v70
s_lshl_b32 s49, s47, 12
v_xor_b32 v64, v2, v3
v_lshlrev_b32 v64, 4, v64
v_lshl_add_u32 v64, v3, 8, v64
v_add_u32 v64, s49, v64
v_lshlrev_b32 v65, 10, v2
v_lshl_add_u32 v65, v3, 4, v65
v_add_u32 v65, s49, v65
s_add_u32 s49, s49, 139264
v_lshl_add_u32 v66, v2, 4, s49
s_lshl_b32 s49, s47, 11
s_add_u32 s49, s49, 131072
v_lshl_add_u32 v67, v2, 3, s49
s_waitcnt vmcnt(32)
v_lshlrev_b32 v44, 16, v40
v_and_b32 v45, 0xffff0000, v40
v_lshlrev_b32 v46, 16, v41
v_and_b32 v47, 0xffff0000, v41
v_lshlrev_b32 v48, 16, v42
v_and_b32 v49, 0xffff0000, v42
v_lshlrev_b32 v50, 16, v43
v_and_b32 v51, 0xffff0000, v43
v_add_f32 v52, v44, v45
v_add_f32 v52, v52, v46
v_add_f32 v52, v52, v47
v_add_f32 v52, v52, v48
v_add_f32 v52, v52, v49
v_add_f32 v52, v52, v50
v_add_f32 v52, v52, v51
s_nop 1
v_add_f32_dpp v52, v52, v52 row_shr:1 row_mask:0xf bank_mask:0xf
s_nop 1
v_add_f32_dpp v52, v52, v52 row_shr:2 row_mask:0xf bank_mask:0xf
s_nop 1
v_add_f32_dpp v52, v52, v52 row_shr:4 row_mask:0xf bank_mask:0xf
s_nop 1
v_add_f32_dpp v52, v52, v52 row_shr:8 row_mask:0xf bank_mask:0xf
s_nop 1
v_add_f32_dpp v52, v52, v52 row_bcast:15 row_mask:0xa bank_mask:0xf
s_nop 1
v_add_f32_dpp v52, v52, v52 row_bcast:31 row_mask:0xc bank_mask:0xf
s_nop 1
v_readlane_b32 s49, v52, 63
s_nop 1
v_mov_b32 v53, 0x3b000000
v_mul_f32 v53, s49, v53
v_sub_f32 v44, v44, v53
v_sub_f32 v45, v45, v53
v_sub_f32 v46, v46, v53
v_sub_f32 v47, v47, v53
v_sub_f32 v48, v48, v53
v_sub_f32 v49, v49, v53
v_sub_f32 v50, v50, v53
v_sub_f32 v51, v51, v53
v_mul_f32 v52, v44, v44
v_fmac_f32 v52, v45, v45
v_fmac_f32 v52, v46, v46
v_fmac_f32 v52, v47, v47
v_fmac_f32 v52, v48, v48
v_fmac_f32 v52, v49, v49
v_fmac_f32 v52, v50, v50
v_fmac_f32 v52, v51, v51
s_nop 1
v_add_f32_dpp v52, v52, v52 row_shr:1 row_mask:0xf bank_mask:0xf
s_nop 1
v_add_f32_dpp v52, v52, v52 row_shr:2 row_mask:0xf bank_mask:0xf
s_nop 1
v_add_f32_dpp v52, v52, v52 row_shr:4 row_mask:0xf bank_mask:0xf
s_nop 1
v_add_f32_dpp v52, v52, v52 row_shr:8 row_mask:0xf bank_mask:0xf
s_nop 1
v_add_f32_dpp v52, v52, v52 row_bcast:15 row_mask:0xa bank_mask:0xf
s_nop 1
v_add_f32_dpp v52, v52, v52 row_bcast:31 row_mask:0xc bank_mask:0xf
s_nop 1
v_readlane_b32 s49, v52, 63
s_nop 1
v_mov_b32 v54, 0x3b000000
v_mul_f32 v54, s49, v54
v_cvt_pk_bf16_f32 v53, v53, v53
v_lshlrev_b32 v53, 16, v53
v_cvt_pk_bf16_f32 v54, v54, v54
v_lshlrev_b32 v54, 16, v54
v_add_f32 v54, 925353388, v54
v_cvt_pk_bf16_f32 v54, v54, v54
v_lshlrev_b32 v54, 16, v54
v_sqrt_f32 v54, v54
s_nop 0
v_cvt_pk_bf16_f32 v54, v54, v54
v_lshlrev_b32 v54, 16, v54
v_rcp_f32 v55, v54
v_lshlrev_b32 v8, 16, v8
v_sub_f32 v8, v8, v53
v_cvt_pk_bf16_f32 v8, v8, v8
v_lshlrev_b32 v8, 16, v8
v_mul_f32 v56, v8, v55
v_fma_f32 v57, -v56, v54, v8
v_fma_f32 v56, v57, v55, v56
v_cvt_pk_bf16_f32 v8, v56, v56
v_lshlrev_b32 v9, 16, v9
v_sub_f32 v9, v9, v53
v_cvt_pk_bf16_f32 v9, v9, v9
v_lshlrev_b32 v9, 16, v9
v_mul_f32 v56, v9, v55
v_fma_f32 v57, -v56, v54, v9
v_fma_f32 v56, v57, v55, v56
v_cvt_pk_bf16_f32 v9, v56, v56
s_waitcnt vmcnt(0)
s_call_b64 s[44:45], L_gemv
s_mov_b64 exec, s[54:55]
ds_write_b32 v70, v12 offset:0
ds_write_b32 v70, v13 offset:32
ds_write_b32 v70, v14 offset:64
ds_write_b32 v70, v15 offset:96
s_mov_b64 exec, -1
s_waitcnt lgkmcnt(0)
v_mov_b32 v76, 1
ds_write_b32 v69, v76 offset:16
L_cb_6:
ds_read_b128 v[76:79], v68 offset:32
s_sub_u32 s66, s66, 1
s_cbranch_scc1 L_end
s_waitcnt lgkmcnt(0)
v_min_u32 v76, v76, v77
v_min3_u32 v76, v76, v78, v79
s_nop 0
v_readfirstlane_b32 s53, v76
s_cmp_ge_u32 s53, 1
s_cbranch_scc0 L_cb_6
v_lshlrev_b32 v76, 3, v0
v_add_u32 v76, 155648, v76
ds_read_b64 v[40:41], v76 offset:0
ds_read_b64 v[42:43], v76 offset:512
ds_read_b64 v[44:45], v76 offset:1024
ds_read_b64 v[46:47], v76 offset:1536
s_waitcnt lgkmcnt(0)
v_add_f32 v40, v40, v42
v_add_f32 v41, v41, v43
v_add_f32 v40, v40, v44
v_add_f32 v41, v41, v45
v_add_f32 v40, v40, v46
v_add_f32 v41, v41, v47
v_cvt_pk_bf16_f32 v40, v40, v41
v_lshl_add_u32 v76, v0, 2, v68
ds_write_b32 v76, v40 offset:128
v_lshl_add_u32 v76, v2, 4, v68
s_waitcnt lgkmcnt(0)
ds_read_b128 v[24:27], v76 offset:128
ds_read_b128 v[28:31], v76 offset:192
ds_read_b128 v[32:35], v76 offset:256
ds_read_b128 v[36:39], v76 offset:320
s_mul_i32 s59, s30, 43
s_lshr_b32 s60, s59, 3
s_add_u32 s59, s59, 43
s_lshr_b32 s59, s59, 3
s_sub_u32 s59, s59, s60
s_lshl_b32 s59, s59, 3
s_lshl_b32 s60, s60, 3
s_mov_b32 s32, s16
s_and_b32 s33, s17, 0xffff
s_mov_b32 s34, 1409024
s_mov_b32 s35, 0x20000
s_mov_b32 s49, 11008
v_mul_lo_u32 v71, v2, s49
v_min_u32 v76, 5, v3
v_lshl_add_u32 v71, v76, 4, v71
s_mul_i32 s74, s47, 352256
s_lshl_b32 s49, s60, 1
s_add_u32 s74, s74, s49
s_mov_b32 s75, 0
s_mov_b32 s68, s20
s_and_b32 s69, s21, 0xffff
s_mov_b32 s70, 1409024
s_mov_b32 s71, 0x20000
v_lshlrev_b32 v72, 12, v2
v_lshl_add_u32 v72, v3, 4, v72
s_lshl_b32 s67, s60, 10
s_lshl_b32 s49, s47, 8
s_add_u32 s67, s67, s49
s_mov_b32 s40, s18
s_and_b32 s41, s19, 0xffff
s_mov_b32 s42, 2752
s_mov_b32 s43, 0x20000
s_lshl_b32 s49, s60, 1
v_lshlrev_b32 v76, 1, v10
buffer_load_ushort v74, v76, s[40:43], s49 offen
v_mov_b32 v75, v10
s_mov_b32 s56, 0
s_add_u32 s57, s47, 1
s_mov_b32 s61, 0
s_mov_b32 s62, 1
s_mov_b32 s64, 0x00010001
s_mov_b32 s65, 0x00010001
s_waitcnt lgkmcnt(0)
s_call_b64 s[44:45], L_ktile
s_add_u32 s48, s74, s75
buffer_load_dwordx4 v[128:131], v71, s[32:35], s48 offen
s_add_u32 s48, s48, 2752
s_call_b64 s[44:45], L_ktile
buffer_load_dwordx4 v[132:135], v71, s[32:35], s48 offen
s_add_u32 s48, s48, 2752
s_call_b64 s[44:45], L_ktile
buffer_load_dwordx4 v[136:139], v71, s[32:35], s48 offen
s_add_u32 s48, s48, 2752
s_call_b64 s[44:45], L_ktile
buffer_load_dwordx4 v[140:143], v71, s[32:35], s48 offen
s_add_u32 s75, s75, 44032
s_cmp_eq_u32 s75, 352256
s_cselect_b32 s75, 0, s75
s_call_b64 s[44:45], L_ktile
s_add_u32 s48, s74, s75
buffer_load_dwordx4 v[144:147], v71, s[32:35], s48 offen
s_add_u32 s48, s48, 2752
s_call_b64 s[44:45], L_ktile
buffer_load_dwordx4 v[148:151], v71, s[32:35], s48 offen
s_add_u32 s48, s48, 2752
s_call_b64 s[44:45], L_ktile
buffer_load_dwordx4 v[152:155], v71, s[32:35], s48 offen
s_add_u32 s48, s48, 2752
s_call_b64 s[44:45], L_ktile
buffer_load_dwordx4 v[156:159], v71, s[32:35], s48 offen
s_add_u32 s75, s75, 44032
s_cmp_eq_u32 s75, 352256
s_cselect_b32 s75, 0, s75
s_call_b64 s[44:45], L_ktile
s_add_u32 s48, s74, s75
buffer_load_dwordx4 v[160:163], v71, s[32:35], s48 offen
s_add_u32 s48, s48, 2752
s_call_b64 s[44:45], L_ktile
buffer_load_dwordx4 v[164:167], v71, s[32:35], s48 offen
s_add_u32 s48, s48, 2752
s_call_b64 s[44:45], L_ktile
buffer_load_dwordx4 v[168:171], v71, s[32:35], s48 offen
s_add_u32 s48, s48, 2752
s_call_b64 s[44:45], L_ktile
buffer_load_dwordx4 v[172:175], v71, s[32:35], s48 offen
s_add_u32 s75, s75, 44032
s_cmp_eq_u32 s75, 352256
s_cselect_b32 s75, 0, s75
s_call_b64 s[44:45], L_ktile
s_add_u32 s48, s74, s75
buffer_load_dwordx4 v[176:179], v71, s[32:35], s48 offen
s_add_u32 s48, s48, 2752
s_call_b64 s[44:45], L_ktile
buffer_load_dwordx4 v[180:183], v71, s[32:35], s48 offen
s_add_u32 s48, s48, 2752
s_call_b64 s[44:45], L_ktile
buffer_load_dwordx4 v[184:187], v71, s[32:35], s48 offen
s_add_u32 s48, s48, 2752
s_call_b64 s[44:45], L_ktile
buffer_load_dwordx4 v[188:191], v71, s[32:35], s48 offen
s_add_u32 s75, s75, 44032
s_cmp_eq_u32 s75, 352256
s_cselect_b32 s75, 0, s75
s_call_b64 s[44:45], L_ktile
s_add_u32 s48, s74, s75
buffer_load_dwordx4 v[192:195], v71, s[32:35], s48 offen
s_add_u32 s48, s48, 2752
s_call_b64 s[44:45], L_ktile
buffer_load_dwordx4 v[196:199], v71, s[32:35], s48 offen
s_add_u32 s48, s48, 2752
s_call_b64 s[44:45], L_ktile
buffer_load_dwordx4 v[200:203], v71, s[32:35], s48 offen
s_add_u32 s48, s48, 2752
s_call_b64 s[44:45], L_ktile
buffer_load_dwordx4 v[204:207], v71, s[32:35], s48 offen
s_add_u32 s75, s75, 44032
s_cmp_eq_u32 s75, 352256
s_cselect_b32 s75, 0, s75
s_call_b64 s[44:45], L_ktile
s_add_u32 s48, s74, s75
buffer_load_dwordx4 v[208:211], v71, s[32:35], s48 offen
s_add_u32 s48, s48, 2752
s_call_b64 s[44:45], L_ktile
buffer_load_dwordx4 v[212:215], v71, s[32:35], s48 offen
s_add_u32 s48, s48, 2752
s_call_b64 s[44:45], L_ktile
buffer_load_dwordx4 v[216:219], v71, s[32:35], s48 offen
s_add_u32 s48, s48, 2752
s_call_b64 s[44:45], L_ktile
buffer_load_dwordx4 v[220:223], v71, s[32:35], s48 offen
s_add_u32 s75, s75, 44032
s_cmp_eq_u32 s75, 352256
s_cselect_b32 s75, 0, s75
s_call_b64 s[44:45], L_ktile
s_add_u32 s48, s74, s75
buffer_load_dwordx4 v[224:227], v71, s[32:35], s48 offen
s_add_u32 s48, s48, 2752
s_call_b64 s[44:45], L_ktile
buffer_load_dwordx4 v[228:231], v71, s[32:35], s48 offen
s_add_u32 s48, s48, 2752
s_call_b64 s[44:45], L_ktile
buffer_load_dwordx4 v[232:235], v71, s[32:35], s48 offen
s_add_u32 s48, s48, 2752
s_call_b64 s[44:45], L_ktile
buffer_load_dwordx4 v[236:239], v71, s[32:35], s48 offen
s_add_u32 s75, s75, 44032
s_cmp_eq_u32 s75, 352256
s_cselect_b32 s75, 0, s75
s_call_b64 s[44:45], L_ktile
s_add_u32 s48, s74, s75
buffer_load_dwordx4 v[240:243], v71, s[32:35], s48 offen
s_add_u32 s48, s48, 2752
s_call_b64 s[44:45], L_ktile
buffer_load_dwordx4 v[244:247], v71, s[32:35], s48 offen
s_add_u32 s48, s48, 2752
s_call_b64 s[44:45], L_ktile
buffer_load_dwordx4 v[248:251], v71, s[32:35], s48 offen
s_add_u32 s48, s48, 2752
s_call_b64 s[44:45], L_ktile
buffer_load_dwordx4 v[252:255], v71, s[32:35], s48 offen
s_add_u32 s75, s75, 44032
s_cmp_eq_u32 s75, 352256
s_cselect_b32 s75, 0, s75
s_call_b64 s[44:45], L_ktile
buffer_load_dwordx4 v[80:83], v72, s[68:71], s67 offen
s_add_u32 s67, s67, 1024
s_call_b64 s[44:45], L_ktile
buffer_load_dwordx4 v[84:87], v72, s[68:71], s67 offen
s_add_u32 s67, s67, 1024
s_call_b64 s[44:45], L_ktile
buffer_load_dwordx4 v[88:91], v72, s[68:71], s67 offen
s_add_u32 s67, s67, 1024
s_call_b64 s[44:45], L_ktile
buffer_load_dwordx4 v[92:95], v72, s[68:71], s67 offen
s_add_u32 s67, s67, 13312
s_call_b64 s[44:45], L_ktile
buffer_load_dwordx4 v[96:99], v72, s[68:71], s67 offen
s_add_u32 s67, s67, 1024
s_call_b64 s[44:45], L_ktile
buffer_load_dwordx4 v[100:103], v72, s[68:71], s67 offen
s_add_u32 s67, s67, 1024
s_call_b64 s[44:45], L_ktile
buffer_load_dwordx4 v[104:107], v72, s[68:71], s67 offen
s_add_u32 s67, s67, 1024
s_call_b64 s[44:45], L_ktile
buffer_load_dwordx4 v[108:111], v72, s[68:71], s67 offen
s_add_u32 s67, s67, 13312
s_call_b64 s[44:45], L_ktile
buffer_load_dwordx4 v[112:115], v72, s[68:71], s67 offen
s_add_u32 s67, s67, 1024
s_call_b64 s[44:45], L_ktile
buffer_load_dwordx4 v[116:119], v72, s[68:71], s67 offen
s_add_u32 s67, s67, 1024
s_call_b64 s[44:45], L_ktile
buffer_load_dwordx4 v[120:123], v72, s[68:71], s67 offen
s_add_u32 s67, s67, 1024
s_call_b64 s[44:45], L_ktile
buffer_load_dwordx4 v[124:127], v72, s[68:71], s67 offen
s_add_u32 s67, s67, 13312
s_call_b64 s[44:45], L_ktile
s_call_b64 s[44:45], L_ktile
s_call_b64 s[44:45], L_ktile
s_call_b64 s[44:45], L_ktile
s_call_b64 s[44:45], L_ktile
s_call_b64 s[44:45], L_ktile
s_call_b64 s[44:45], L_ktile
s_call_b64 s[44:45], L_ktile
s_call_b64 s[44:45], L_ktile
s_call_b64 s[44:45], L_ktile
s_call_b64 s[44:45], L_ktile
s_call_b64 s[44:45], L_ktile
s_call_b64 s[44:45], L_ktile
s_call_b64 s[44:45], L_ktile
s_call_b64 s[44:45], L_ktile
s_call_b64 s[44:45], L_ktile
s_call_b64 s[44:45], L_ktile
s_call_b64 s[44:45], L_ktile
s_call_b64 s[44:45], L_ktile
s_call_b64 s[44:45], L_ktile
s_lshl_b32 s49, s47, 11
s_add_u32 s49, s49, 131072
v_lshl_add_u32 v76, v0, 5, s49
s_waitcnt lgkmcnt(0)
ds_read_b128 v[56:59], v76
ds_read_b128 v[60:63], v76 offset:16
s_waitcnt vmcnt(0)
s_call_b64 s[44:45], L_gemv
s_mov_b64 exec, s[54:55]
ds_write_b32 v70, v12 offset:2048
ds_write_b32 v70, v13 offset:2080
ds_write_b32 v70, v14 offset:2112
ds_write_b32 v70, v15 offset:2144
s_mov_b64 exec, -1
s_mov_b32 s32, s12
s_and_b32 s33, s13, 0xffff
s_mov_b32 s34, 4194304
s_mov_b32 s35, 0x20000
s_lshl_b32 s48, s30, 17
s_lshl_b32 s49, s47, 8
s_add_u32 s48, s48, s49
s_mov_b32 s67, s48
s_waitcnt lgkmcnt(4)
v_lshlrev_b32 v40, 16, v56
v_and_b32 v41, 0xffff0000, v56
v_lshlrev_b32 v42, 16, v57
v_and_b32 v43, 0xffff0000, v57
v_lshlrev_b32 v44, 16, v58
v_and_b32 v45, 0xffff0000, v58
v_lshlrev_b32 v46, 16, v59
v_and_b32 v47, 0xffff0000, v59
v_lshlrev_b32 v48, 16, v60
v_and_b32 v49, 0xffff0000, v60
v_lshlrev_b32 v50, 16, v61
v_and_b32 v51, 0xffff0000, v61
v_lshlrev_b32 v52, 16, v62
v_and_b32 v53, 0xffff0000, v62
v_lshlrev_b32 v54, 16, v63
v_and_b32 v55, 0xffff0000, v63
v_max3_f32 v76, v40, v41, v42
v_max3_f32 v76, v76, v43, v44
v_max3_f32 v76, v76, v45, v46
v_max3_f32 v76, v76, v47, v48
v_max3_f32 v76, v76, v49, v50
v_max3_f32 v76, v76, v51, v52
v_max3_f32 v76, v76, v53, v54
v_max_f32 v76, v76, v55
s_nop 1
v_max_f32_dpp v76, v76, v76 row_shr:1 row_mask:0xf bank_mask:0xf
s_nop 1
v_max_f32_dpp v76, v76, v76 row_shr:2 row_mask:0xf bank_mask:0xf
s_nop 1
v_max_f32_dpp v76, v76, v76 row_shr:4 row_mask:0xf bank_mask:0xf
s_nop 1
v_max_f32_dpp v76, v76, v76 row_shr:8 row_mask:0xf bank_mask:0xf
s_nop 1
v_max_f32_dpp v76, v76, v76 row_bcast:15 row_mask:0xa bank_mask:0xf
s_nop 1
v_max_f32_dpp v76, v76, v76 row_bcast:31 row_mask:0xc bank_mask:0xf
s_nop 1
v_readlane_b32 s49, v76, 63
s_nop 1
v_mov_b32 v77, 1069066811
v_subrev_f32 v56, s49, v40
v_mul_f32 v56, v56, v77
v_exp_f32 v56, v56
v_mov_b32 v76, 0
v_subrev_f32 v57, s49, v41
v_mul_f32 v57, v57, v77
v_exp_f32 v57, v57
v_add_f32 v76, v76, v56
v_subrev_f32 v58, s49, v42
v_mul_f32 v58, v58, v77
v_exp_f32 v58, v58
v_add_f32 v76, v76, v57
v_subrev_f32 v59, s49, v43
v_mul_f32 v59, v59, v77
v_exp_f32 v59, v59
v_add_f32 v76, v76, v58
v_subrev_f32 v60, s49, v44
v_mul_f32 v60, v60, v77
v_exp_f32 v60, v60
v_add_f32 v76, v76, v59
v_subrev_f32 v61, s49, v45
v_mul_f32 v61, v61, v77
v_exp_f32 v61, v61
v_add_f32 v76, v76, v60
v_subrev_f32 v62, s49, v46
v_mul_f32 v62, v62, v77
v_exp_f32 v62, v62
v_add_f32 v76, v76, v61
v_subrev_f32 v63, s49, v47
v_mul_f32 v63, v63, v77
v_exp_f32 v63, v63
v_add_f32 v76, v76, v62
v_subrev_f32 v56, s49, v48
v_mul_f32 v56, v56, v77
v_exp_f32 v56, v56
v_add_f32 v76, v76, v63
v_subrev_f32 v57, s49, v49
v_mul_f32 v57, v57, v77
v_exp_f32 v57, v57
v_add_f32 v76, v76, v56
v_subrev_f32 v58, s49, v50
v_mul_f32 v58, v58, v77
v_exp_f32 v58, v58
v_add_f32 v76, v76, v57
v_subrev_f32 v59, s49, v51
v_mul_f32 v59, v59, v77
v_exp_f32 v59, v59
v_add_f32 v76, v76, v58
v_subrev_f32 v60, s49, v52
v_mul_f32 v60, v60, v77
v_exp_f32 v60, v60
v_add_f32 v76, v76, v59
v_subrev_f32 v61, s49, v53
v_mul_f32 v61, v61, v77
v_exp_f32 v61, v61
v_add_f32 v76, v76, v60
v_subrev_f32 v62, s49, v54
v_mul_f32 v62, v62, v77
v_exp_f32 v62, v62
v_add_f32 v76, v76, v61
v_subrev_f32 v63, s49, v55
v_mul_f32 v63, v63, v77
v_exp_f32 v63, v63
v_add_f32 v76, v76, v62
s_nop 0
v_add_f32 v76, v76, v63
s_nop 1
v_add_f32_dpp v76, v76, v76 row_shr:1 row_mask:0xf bank_mask:0xf
s_nop 1
v_add_f32_dpp v76, v76, v76 row_shr:2 row_mask:0xf bank_mask:0xf
s_nop 1
v_add_f32_dpp v76, v76, v76 row_shr:4 row_mask:0xf bank_mask:0xf
s_nop 1
v_add_f32_dpp v76, v76, v76 row_shr:8 row_mask:0xf bank_mask:0xf
s_nop 1
v_add_f32_dpp v76, v76, v76 row_bcast:15 row_mask:0xa bank_mask:0xf
s_nop 1
v_add_f32_dpp v76, v76, v76 row_bcast:31 row_mask:0xc bank_mask:0xf
s_nop 1
v_readlane_b32 s50, v76, 63
s_nop 1
v_mov_b32 v78, s49
v_mov_b32 v79, s50
s_lshl_b32 s49, s47, 3
v_add_u32 v76, s49, v68
ds_write_b64 v76, v[78:79] offset:64
s_waitcnt lgkmcnt(0)
v_mov_b32 v76, 2
ds_write_b32 v69, v76 offset:16
L_cb_7:
ds_read_b128 v[76:79], v68 offset:32
s_sub_u32 s66, s66, 1
s_cbranch_scc1 L_end
s_waitcnt lgkmcnt(0)
v_min_u32 v76, v76, v77
v_min3_u32 v76, v76, v78, v79
s_nop 0
v_readfirstlane_b32 s53, v76
s_cmp_ge_u32 s53, 2
s_cbranch_scc0 L_cb_7
ds_read_b128 v[56:59], v68 offset:64
ds_read_b128 v[60:63], v68 offset:80
ds_read_b32 v16, v11 offset:2048
ds_read_b32 v17, v11 offset:2560
ds_read_b32 v18, v11 offset:3072
ds_read_b32 v19, v11 offset:3584
v_mov_b32 v77, 1069066811
s_waitcnt lgkmcnt(4)
v_max3_f32 v76, v56, v58, v60
v_max_f32 v76, v76, v62
v_sub_f32 v56, v56, v76
v_mul_f32 v56, v56, v77
v_exp_f32 v56, v56
v_sub_f32 v58, v58, v76
v_mul_f32 v58, v58, v77
v_exp_f32 v58, v58
v_sub_f32 v60, v60, v76
v_mul_f32 v60, v60, v77
v_exp_f32 v60, v60
v_sub_f32 v62, v62, v76
v_mul_f32 v62, v62, v77
v_exp_f32 v62, v62
s_nop 0
v_mul_f32 v78, v56, v57
v_fmac_f32 v78, v58, v59
v_fmac_f32 v78, v60, v61
v_fmac_f32 v78, v62, v63
v_rcp_f32 v79, v78
s_nop 0
v_fma_f32 v56, -v78, v79, 1.0
v_fma_f32 v79, v56, v79, v79
v_sub_f32 v40, v40, v76
v_mul_f32 v40, v40, v77
v_exp_f32 v40, v40
v_sub_f32 v41, v41, v76
v_mul_f32 v41, v41, v77
v_exp_f32 v41, v41
v_sub_f32 v42, v42, v76
v_mul_f32 v42, v42, v77
v_exp_f32 v42, v42
v_sub_f32 v43, v43, v76
v_mul_f32 v43, v43, v77
v_exp_f32 v43, v43
v_sub_f32 v44, v44, v76
v_mul_f32 v44, v44, v77
v_exp_f32 v44, v44
v_sub_f32 v45, v45, v76
v_mul_f32 v45, v45, v77
v_exp_f32 v45, v45
v_sub_f32 v46, v46, v76
v_mul_f32 v46, v46, v77
v_exp_f32 v46, v46
v_sub_f32 v47, v47, v76
v_mul_f32 v47, v47, v77
v_exp_f32 v47, v47
v_sub_f32 v48, v48, v76
v_mul_f32 v48, v48, v77
v_exp_f32 v48, v48
v_sub_f32 v49, v49, v76
v_mul_f32 v49, v49, v77
v_exp_f32 v49, v49
v_sub_f32 v50, v50, v76
v_mul_f32 v50, v50, v77
v_exp_f32 v50, v50
v_sub_f32 v51, v51, v76
v_mul_f32 v51, v51, v77
v_exp_f32 v51, v51
v_sub_f32 v52, v52, v76
v_mul_f32 v52, v52, v77
v_exp_f32 v52, v52
v_sub_f32 v53, v53, v76
v_mul_f32 v53, v53, v77
v_exp_f32 v53, v53
v_sub_f32 v54, v54, v76
v_mul_f32 v54, v54, v77
v_exp_f32 v54, v54
v_sub_f32 v55, v55, v76
v_mul_f32 v55, v55, v77
v_exp_f32 v55, v55
s_nop 0
v_mul_f32 v40, v40, v79
v_cvt_pk_bf16_f32 v40, v40, v40
v_mul_f32 v41, v41, v79
v_cvt_pk_bf16_f32 v41, v41, v41
v_mul_f32 v42, v42, v79
v_cvt_pk_bf16_f32 v42, v42, v42
v_mul_f32 v43, v43, v79
v_cvt_pk_bf16_f32 v43, v43, v43
v_mul_f32 v44, v44, v79
v_cvt_pk_bf16_f32 v44, v44, v44
v_mul_f32 v45, v45, v79
v_cvt_pk_bf16_f32 v45, v45, v45
v_mul_f32 v46, v46, v79
v_cvt_pk_bf16_f32 v46, v46, v46
v_mul_f32 v47, v47, v79
v_cvt_pk_bf16_f32 v47, v47, v47
v_mul_f32 v48, v48, v79
v_cvt_pk_bf16_f32 v48, v48, v48
v_mul_f32 v49, v49, v79
v_cvt_pk_bf16_f32 v49, v49, v49
v_mul_f32 v50, v50, v79
v_cvt_pk_bf16_f32 v50, v50, v50
v_mul_f32 v51, v51, v79
v_cvt_pk_bf16_f32 v51, v51, v51
v_mul_f32 v52, v52, v79
v_cvt_pk_bf16_f32 v52, v52, v52
v_mul_f32 v53, v53, v79
v_cvt_pk_bf16_f32 v53, v53, v53
v_mul_f32 v54, v54, v79
v_cvt_pk_bf16_f32 v54, v54, v54
v_mul_f32 v55, v55, v79
v_cvt_pk_bf16_f32 v55, v55, v55
s_lshl_b32 s49, s47, 12
s_add_u32 s49, s49, 139264
v_lshl_add_u32 v76, v0, 6, s49
ds_write_b128 v76, v[40:43] offset:0
ds_write_b128 v76, v[44:47] offset:16
ds_write_b128 v76, v[48:51] offset:32
ds_write_b128 v76, v[52:55] offset:48
s_waitcnt lgkmcnt(4)
v_add_f32 v16, v16, v17
v_add_f32 v16, v16, v18
v_add_f32 v16, v16, v19
v_cvt_pk_bf16_f32 v16, v16, v16
v_lshlrev_b32 v16, 16, v16
v_lshlrev_b32 v74, 16, v74
v_add_f32 v16, v16, v74
v_cvt_pk_bf16_f32 v16, v16, v16
v_lshlrev_b32 v16, 16, v16
v_cmp_gt_f32 vcc, v16, 0
s_nop 1
v_cndmask_b32 v16, 0, v16, vcc
v_mul_f32 v16, v16, v16
v_cvt_pk_bf16_f32 v10, v16, v16
v_cmp_gt_u32 vcc, s59, v75
s_nop 1
v_cndmask_b32 v10, 0, v10, vcc
s_nop 1
v_and_b32_dpp v16, v10, v4 row_newbcast:0 row_mask:0xf bank_mask:0xf
v_and_b32_dpp v17, v10, v5 row_newbcast:0 row_mask:0xf bank_mask:0xf
v_and_b32_dpp v18, v10, v6 row_newbcast:0 row_mask:0xf bank_mask:0xf
v_and_b32_dpp v19, v10, v7 row_newbcast:0 row_mask:0xf bank_mask:0xf
v_and_b32_dpp v20, v10, v4 row_newbcast:1 row_mask:0xf bank_mask:0xf
v_and_b32_dpp v21, v10, v5 row_newbcast:1 row_mask:0xf bank_mask:0xf
v_and_b32_dpp v22, v10, v6 row_newbcast:1 row_mask:0xf bank_mask:0xf
v_and_b32_dpp v23, v10, v7 row_newbcast:1 row_mask:0xf bank_mask:0xf
v_mfma_f32_16x16x32_bf16 v[12:15], v[80:83], v[16:19], 0
v_and_b32_dpp v16, v10, v4 row_newbcast:2 row_mask:0xf bank_mask:0xf
v_and_b32_dpp v17, v10, v5 row_newbcast:2 row_mask:0xf bank_mask:0xf
v_and_b32_dpp v18, v10, v6 row_newbcast:2 row_mask:0xf bank_mask:0xf
v_and_b32_dpp v19, v10, v7 row_newbcast:2 row_mask:0xf bank_mask:0xf
v_mfma_f32_16x16x32_bf16 v[12:15], v[84:87], v[20:23], v[12:15]
v_and_b32_dpp v20, v10, v4 row_newbcast:3 row_mask:0xf bank_mask:0xf
v_and_b32_dpp v21, v10, v5 row_newbcast:3 row_mask:0xf bank_mask:0xf
v_and_b32_dpp v22, v10, v6 row_newbcast:3 row_mask:0xf bank_mask:0xf
v_and_b32_dpp v23, v10, v7 row_newbcast:3 row_mask:0xf bank_mask:0xf
v_mfma_f32_16x16x32_bf16 v[12:15], v[88:91], v[16:19], v[12:15]
v_and_b32_dpp v16, v10, v4 row_newbcast:4 row_mask:0xf bank_mask:0xf
v_and_b32_dpp v17, v10, v5 row_newbcast:4 row_mask:0xf bank_mask:0xf
v_and_b32_dpp v18, v10, v6 row_newbcast:4 row_mask:0xf bank_mask:0xf
v_and_b32_dpp v19, v10, v7 row_newbcast:4 row_mask:0xf bank_mask:0xf
v_mfma_f32_16x16x32_bf16 v[12:15], v[92:95], v[20:23], v[12:15]
v_and_b32_dpp v20, v10, v4 row_newbcast:5 row_mask:0xf bank_mask:0xf
v_and_b32_dpp v21, v10, v5 row_newbcast:5 row_mask:0xf bank_mask:0xf
v_and_b32_dpp v22, v10, v6 row_newbcast:5 row_mask:0xf bank_mask:0xf
v_and_b32_dpp v23, v10, v7 row_newbcast:5 row_mask:0xf bank_mask:0xf
v_mfma_f32_16x16x32_bf16 v[12:15], v[96:99], v[16:19], v[12:15]
v_and_b32_dpp v16, v10, v4 row_newbcast:6 row_mask:0xf bank_mask:0xf
v_and_b32_dpp v17, v10, v5 row_newbcast:6 row_mask:0xf bank_mask:0xf
v_and_b32_dpp v18, v10, v6 row_newbcast:6 row_mask:0xf bank_mask:0xf
v_and_b32_dpp v19, v10, v7 row_newbcast:6 row_mask:0xf bank_mask:0xf
v_mfma_f32_16x16x32_bf16 v[12:15], v[100:103], v[20:23], v[12:15]
v_and_b32_dpp v20, v10, v4 row_newbcast:7 row_mask:0xf bank_mask:0xf
v_and_b32_dpp v21, v10, v5 row_newbcast:7 row_mask:0xf bank_mask:0xf
v_and_b32_dpp v22, v10, v6 row_newbcast:7 row_mask:0xf bank_mask:0xf
v_and_b32_dpp v23, v10, v7 row_newbcast:7 row_mask:0xf bank_mask:0xf
v_mfma_f32_16x16x32_bf16 v[12:15], v[104:107], v[16:19], v[12:15]
v_and_b32_dpp v16, v10, v4 row_newbcast:8 row_mask:0xf bank_mask:0xf
v_and_b32_dpp v17, v10, v5 row_newbcast:8 row_mask:0xf bank_mask:0xf
v_and_b32_dpp v18, v10, v6 row_newbcast:8 row_mask:0xf bank_mask:0xf
v_and_b32_dpp v19, v10, v7 row_newbcast:8 row_mask:0xf bank_mask:0xf
v_mfma_f32_16x16x32_bf16 v[12:15], v[108:111], v[20:23], v[12:15]
v_and_b32_dpp v20, v10, v4 row_newbcast:9 row_mask:0xf bank_mask:0xf
v_and_b32_dpp v21, v10, v5 row_newbcast:9 row_mask:0xf bank_mask:0xf
v_and_b32_dpp v22, v10, v6 row_newbcast:9 row_mask:0xf bank_mask:0xf
v_and_b32_dpp v23, v10, v7 row_newbcast:9 row_mask:0xf bank_mask:0xf
v_mfma_f32_16x16x32_bf16 v[12:15], v[112:115], v[16:19], v[12:15]
v_and_b32_dpp v16, v10, v4 row_newbcast:10 row_mask:0xf bank_mask:0xf
v_and_b32_dpp v17, v10, v5 row_newbcast:10 row_mask:0xf bank_mask:0xf
v_and_b32_dpp v18, v10, v6 row_newbcast:10 row_mask:0xf bank_mask:0xf
v_and_b32_dpp v19, v10, v7 row_newbcast:10 row_mask:0xf bank_mask:0xf
v_mfma_f32_16x16x32_bf16 v[12:15], v[116:119], v[20:23], v[12:15]
v_and_b32_dpp v20, v10, v4 row_newbcast:11 row_mask:0xf bank_mask:0xf
v_and_b32_dpp v21, v10, v5 row_newbcast:11 row_mask:0xf bank_mask:0xf
v_and_b32_dpp v22, v10, v6 row_newbcast:11 row_mask:0xf bank_mask:0xf
v_and_b32_dpp v23, v10, v7 row_newbcast:11 row_mask:0xf bank_mask:0xf
v_mfma_f32_16x16x32_bf16 v[12:15], v[120:123], v[16:19], v[12:15]
s_nop 1
v_mfma_f32_16x16x32_bf16 v[12:15], v[124:127], v[20:23], v[12:15]
s_nop 7
v_mov_b32 v80, v12
v_mov_b32 v81, v13
v_mov_b32 v82, v14
v_mov_b32 v83, v15
s_mov_b32 s40, s26
s_and_b32 s41, s27, 0xffff
s_mov_b32 s42, 256
s_mov_b32 s43, 0x20000
v_mov_b32 v78, 0
buffer_load_dwordx2 v[100:101], v78, s[40:43], 0 offen sc1
L_skip_8:
v_lshlrev_b32 v71, 7, v2
v_lshl_add_u32 v71, v3, 4, v71
v_mov_b32 v60, 0
v_mov_b32 v61, 0
v_mov_b32 v62, 0
v_mov_b32 v63, 0
s_getpc_b64 s[72:73]
L_pc2:
s_add_u32 s72, s72, L_tail-L_pc2
s_addc_u32 s73, s73, 0
s_load_dword s78, s[72:73], 0
s_load_dword s78, s[72:73], 128
s_load_dword s78, s[72:73], 256
s_load_dword s78, s[72:73], 384
s_load_dword s78, s[72:73], 512
s_load_dword s78, s[72:73], 640
s_load_dword s78, s[72:73], 768
s_load_dword s78, s[72:73], 896
s_load_dword s78, s[72:73], 1024
s_load_dword s78, s[72:73], 1152
s_waitcnt lgkmcnt(0)
s_call_b64 s[44:45], L_vtile
buffer_load_dwordx4 v[128:131], v72, s[32:35], s67 offen
s_add_u32 s67, s67, 1024
s_call_b64 s[44:45], L_vtile
buffer_load_dwordx4 v[132:135], v72, s[32:35], s67 offen
s_add_u32 s67, s67, 1024
s_call_b64 s[44:45], L_vtile
buffer_load_dwordx4 v[136:139], v72, s[32:35], s67 offen
s_add_u32 s67, s67, 1024
s_call_b64 s[44:45], L_vtile
buffer_load_dwordx4 v[140:143], v72, s[32:35], s67 offen
s_add_u32 s67, s67, 13312
s_call_b64 s[44:45], L_vtile
buffer_load_dwordx4 v[144:147], v72, s[32:35], s67 offen
s_add_u32 s67, s67, 1024
s_call_b64 s[44:45], L_vtile
buffer_load_dwordx4 v[148:151], v72, s[32:35], s67 offen
s_add_u32 s67, s67, 1024
s_call_b64 s[44:45], L_vtile
buffer_load_dwordx4 v[152:155], v72, s[32:35], s67 offen
s_add_u32 s67, s67, 1024
s_call_b64 s[44:45], L_vtile
buffer_load_dwordx4 v[156:159], v72, s[32:35], s67 offen
s_add_u32 s67, s67, 13312
s_call_b64 s[44:45], L_vtile
buffer_load_dwordx4 v[160:163], v72, s[32:35], s67 offen
s_add_u32 s67, s67, 1024
s_call_b64 s[44:45], L_vtile
buffer_load_dwordx4 v[164:167], v72, s[32:35], s67 offen
s_add_u32 s67, s67, 1024
s_call_b64 s[44:45], L_vtile
buffer_load_dwordx4 v[168:171], v72, s[32:35], s67 offen
s_add_u32 s67, s67, 1024
s_call_b64 s[44:45], L_vtile
buffer_load_dwordx4 v[172:175], v72, s[32:35], s67 offen
s_add_u32 s67, s67, 13312
s_call_b64 s[44:45], L_vtile
buffer_load_dwordx4 v[176:179], v72, s[32:35], s67 offen
s_add_u32 s67, s67, 1024
s_call_b64 s[44:45], L_vtile
buffer_load_dwordx4 v[180:183], v72, s[32:35], s67 offen
s_add_u32 s67, s67, 1024
s_call_b64 s[44:45], L_vtile
buffer_load_dwordx4 v[184:187], v72, s[32:35], s67 offen
s_add_u32 s67, s67, 1024
s_call_b64 s[44:45], L_vtile
buffer_load_dwordx4 v[188:191], v72, s[32:35], s67 offen
s_add_u32 s67, s67, 13312
s_call_b64 s[44:45], L_vtile
buffer_load_dwordx4 v[192:195], v72, s[32:35], s67 offen
s_add_u32 s67, s67, 1024
s_call_b64 s[44:45], L_vtile
buffer_load_dwordx4 v[196:199], v72, s[32:35], s67 offen
s_add_u32 s67, s67, 1024
s_call_b64 s[44:45], L_vtile
buffer_load_dwordx4 v[200:203], v72, s[32:35], s67 offen
s_add_u32 s67, s67, 1024
s_call_b64 s[44:45], L_vtile
buffer_load_dwordx4 v[204:207], v72, s[32:35], s67 offen
s_add_u32 s67, s67, 13312
s_call_b64 s[44:45], L_vtile
buffer_load_dwordx4 v[208:211], v72, s[32:35], s67 offen
s_add_u32 s67, s67, 1024
s_call_b64 s[44:45], L_vtile
buffer_load_dwordx4 v[212:215], v72, s[32:35], s67 offen
s_add_u32 s67, s67, 1024
s_call_b64 s[44:45], L_vtile
buffer_load_dwordx4 v[216:219], v72, s[32:35], s67 offen
s_add_u32 s67, s67, 1024
s_call_b64 s[44:45], L_vtile
buffer_load_dwordx4 v[220:223], v72, s[32:35], s67 offen
s_add_u32 s67, s67, 13312
s_call_b64 s[44:45], L_vtile
buffer_load_dwordx4 v[224:227], v72, s[32:35], s67 offen
s_add_u32 s67, s67, 1024
s_call_b64 s[44:45], L_vtile
buffer_load_dwordx4 v[228:231], v72, s[32:35], s67 offen
s_add_u32 s67, s67, 1024
s_call_b64 s[44:45], L_vtile
buffer_load_dwordx4 v[232:235], v72, s[32:35], s67 offen
s_add_u32 s67, s67, 1024
s_call_b64 s[44:45], L_vtile
buffer_load_dwordx4 v[236:239], v72, s[32:35], s67 offen
s_add_u32 s67, s67, 13312
s_call_b64 s[44:45], L_vtile
buffer_load_dwordx4 v[240:243], v72, s[32:35], s67 offen
s_add_u32 s67, s67, 1024
s_call_b64 s[44:45], L_vtile
buffer_load_dwordx4 v[244:247], v72, s[32:35], s67 offen
s_add_u32 s67, s67, 1024
s_call_b64 s[44:45], L_vtile
buffer_load_dwordx4 v[248:251], v72, s[32:35], s67 offen
s_add_u32 s67, s67, 1024
s_call_b64 s[44:45], L_vtile
buffer_load_dwordx4 v[252:255], v72, s[32:35], s67 offen
s_add_u32 s67, s67, 13312
s_call_b64 s[44:45], L_vtile
s_call_b64 s[44:45], L_vtile
s_call_b64 s[44:45], L_vtile
s_call_b64 s[44:45], L_vtile
s_call_b64 s[44:45], L_vtile
s_call_b64 s[44:45], L_vtile
s_call_b64 s[44:45], L_vtile
s_call_b64 s[44:45], L_vtile
s_call_b64 s[44:45], L_vtile
s_call_b64 s[44:45], L_vtile
s_call_b64 s[44:45], L_vtile
s_call_b64 s[44:45], L_vtile
s_call_b64 s[44:45], L_vtile
s_call_b64 s[44:45], L_vtile
s_call_b64 s[44:45], L_vtile
s_call_b64 s[44:45], L_vtile
s_call_b64 s[44:45], L_vtile
s_waitcnt vmcnt(0)
v_readfirstlane_b32 s76, v100
v_readfirstlane_b32 s77, v101
s_min_u32 s49, s76, s77
s_cmp_lg_u32 s49, 0
s_cbranch_scc1 L_tagok
s_memrealtime s[76:77]
s_mov_b32 s40, s26
s_and_b32 s41, s27, 0xffff
s_mov_b32 s42, 256
s_mov_b32 s43, 0x20000
v_mov_b32 v78, 0
v_mov_b32 v102, 0
v_mov_b32 v103, 0
s_waitcnt lgkmcnt(0)
s_or_b32 s76, s76, 1
s_or_b32 s77, s77, 0x80000000
v_mov_b32 v100, s76
v_mov_b32 v101, s77
s_mov_b64 exec, 1
buffer_atomic_cmpswap_x2 v[100:103], v78, s[40:43], 0 offen sc0 sc1
s_mov_b64 exec, -1
s_waitcnt vmcnt(0)
v_readfirstlane_b32 s49, v100
v_readfirstlane_b32 s50, v101
s_or_b32 s51, s49, s50
s_cmp_eq_u32 s51, 0
s_cselect_b32 s76, s76, s49
s_cselect_b32 s77, s77, s50
L_tagok:
v_mov_b32 v85, s76
v_mov_b32 v87, s77
v_mov_b32 v89, s76
v_mov_b32 v91, s77
v_mov_b32 v93, s76
v_mov_b32 v95, s77
v_mov_b32 v97, s76
v_mov_b32 v99, s77
v_mov_b32 v84, v80
v_mov_b32 v86, v81
v_mov_b32 v88, v82
v_mov_b32 v90, v83
s_call_b64 s[44:45], L_vtile
s_call_b64 s[44:45], L_vtile
s_call_b64 s[44:45], L_vtile
s_call_b64 s[44:45], L_vtile
s_call_b64 s[44:45], L_vtile
s_call_b64 s[44:45], L_vtile
s_call_b64 s[44:45], L_vtile
s_call_b64 s[44:45], L_vtile
s_call_b64 s[44:45], L_vtile
s_call_b64 s[44:45], L_vtile
s_call_b64 s[44:45], L_vtile
s_call_b64 s[44:45], L_vtile
s_call_b64 s[44:45], L_vtile
s_call_b64 s[44:45], L_vtile
s_call_b64 s[44:45], L_vtile
L_tail:
s_nop 4
s_mov_b64 exec, s[54:55]
ds_write_b32 v70, v60 offset:4096
ds_write_b32 v70, v61 offset:4128
ds_write_b32 v70, v62 offset:4160
ds_write_b32 v70, v63 offset:4192
s_mov_b64 exec, -1
s_mov_b64 exec, s[54:55]
buffer_store_dwordx4 v[84:87], v71, s[36:39], s58 offen offset:1024 sc1
buffer_store_dwordx4 v[88:91], v71, s[36:39], s58 offen offset:1536 sc1
s_mov_b64 exec, -1
s_waitcnt lgkmcnt(0)
s_barrier
ds_read_b32 v40, v11 offset:4096
ds_read_b32 v41, v11 offset:4608
ds_read_b32 v42, v11 offset:5120
ds_read_b32 v43, v11 offset:5632
ds_read_b32 v44, v11 offset:4352
ds_read_b32 v45, v11 offset:4864
ds_read_b32 v46, v11 offset:5376
ds_read_b32 v47, v11 offset:5888
s_waitcnt lgkmcnt(4)
v_add_f32 v40, v40, v41
v_add_f32 v40, v40, v42
v_add_f32 v40, v40, v43
v_cvt_pk_bf16_f32 v8, v40, v40
s_waitcnt lgkmcnt(0)
v_add_f32 v44, v44, v45
v_add_f32 v44, v44, v46
v_add_f32 v44, v44, v47
v_cvt_pk_bf16_f32 v9, v44, v44
s_call_b64 s[44:45], L_gemv
v_mov_b32 v92, v12
v_mov_b32 v94, v13
v_mov_b32 v96, v14
v_mov_b32 v98, v15
s_mov_b64 exec, s[54:55]
buffer_store_dwordx4 v[92:95], v71, s[36:39], s58 offen sc1
buffer_store_dwordx4 v[96:99], v71, s[36:39], s58 offen offset:512 sc1
s_mov_b64 exec, -1
s_and_b32 s49, s30, 7
s_cmp_lg_u32 s49, s31
s_cbranch_scc1 L_end
s_lshr_b32 s50, s30, 3
v_bfe_u32 v76, v0, 3, 1
v_bfe_u32 v77, v0, 4, 1
v_lshl_add_u32 v76, v76, 1, v77
v_and_b32 v77, 7, v0
v_lshl_add_u32 v76, v76, 3, v77
s_lshl_b32 s49, s50, 7
s_lshl_b32 s51, s47, 5
s_add_u32 s49, s49, s51
v_add_lshl_u32 v70, v76, s49, 1
s_mov_b32 s40, s4
s_and_b32 s41, s5, 0xffff
s_mov_b32 s42, 8192
s_mov_b32 s43, 0x20000
s_lshl_b32 s51, s31, 10
buffer_load_ushort v64, v70, s[40:43], s51 offen
s_mov_b32 s32, s22
s_and_b32 s33, s23, 0xffff
s_mov_b32 s34, 1024
s_mov_b32 s35, 0x20000
buffer_load_ushort v65, v70, s[32:35], 0 offen
v_lshrrev_b32 v76, 3, v0
v_lshlrev_b32 v76, 13, v76
v_lshl_add_u32 v71, v77, 4, v76
s_lshl_b32 s48, s31, 7
s_add_u32 s48, s48, s50
s_lshl_b32 s48, s48, 11
s_lshl_b32 s49, s47, 7
s_add_u32 s48, s48, s49
s_add_u32 s49, s48, 65536
s_add_u32 s50, s48, 131072
s_add_u32 s51, s48, 196608
s_branch L_poll1
L_poll:
s_mov_b64 exec, vcc
L_poll1:
buffer_load_dwordx4 v[128:131], v71, s[36:39], s48 offen offset:0 sc1
buffer_load_dwordx4 v[132:135], v71, s[36:39], s48 offen offset:512 sc1
buffer_load_dwordx4 v[136:139], v71, s[36:39], s48 offen offset:1024 sc1
buffer_load_dwordx4 v[140:143], v71, s[36:39], s48 offen offset:1536 sc1
buffer_load_dwordx4 v[144:147], v71, s[36:39], s49 offen offset:0 sc1
buffer_load_dwordx4 v[148:151], v71, s[36:39], s49 offen offset:512 sc1
buffer_load_dwordx4 v[152:155], v71, s[36:39], s49 offen offset:1024 sc1
buffer_load_dwordx4 v[156:159], v71, s[36:39], s49 offen offset:1536 sc1
buffer_load_dwordx4 v[160:163], v71, s[36:39], s50 offen offset:0 sc1
buffer_load_dwordx4 v[164:167], v71, s[36:39], s50 offen offset:512 sc1
buffer_load_dwordx4 v[168:171], v71, s[36:39], s50 offen offset:1024 sc1
buffer_load_dwordx4 v[172:175], v71, s[36:39], s50 offen offset:1536 sc1
buffer_load_dwordx4 v[176:179], v71, s[36:39], s51 offen offset:0 sc1
buffer_load_dwordx4 v[180:183], v71, s[36:39], s51 offen offset:512 sc1
buffer_load_dwordx4 v[184:187], v71, s[36:39], s51 offen offset:1024 sc1
buffer_load_dwordx4 v[188:191], v71, s[36:39], s51 offen offset:1536 sc1
s_sub_u32 s66, s66, 16
s_cbranch_scc1 L_end
v_mov_b32 v46, 0
s_waitcnt vmcnt(12)
v_xor_b32 v44, s76, v129
v_xor_b32 v45, s77, v131
v_or3_b32 v46, v46, v44, v45
v_xor_b32 v44, s76, v133
v_xor_b32 v45, s77, v135
v_or3_b32 v46, v46, v44, v45
v_xor_b32 v44, s76, v137
v_xor_b32 v45, s77, v139
v_or3_b32 v46, v46, v44, v45
v_xor_b32 v44, s76, v141
v_xor_b32 v45, s77, v143
v_or3_b32 v46, v46, v44, v45
s_waitcnt vmcnt(8)
v_xor_b32 v44, s76, v145
v_xor_b32 v45, s77, v147
v_or3_b32 v46, v46, v44, v45
v_xor_b32 v44, s76, v149
v_xor_b32 v45, s77, v151
v_or3_b32 v46, v46, v44, v45
v_xor_b32 v44, s76, v153
v_xor_b32 v45, s77, v155
v_or3_b32 v46, v46, v44, v45
v_xor_b32 v44, s76, v157
v_xor_b32 v45, s77, v159
v_or3_b32 v46, v46, v44, v45
s_waitcnt vmcnt(4)
v_xor_b32 v44, s76, v161
v_xor_b32 v45, s77, v163
v_or3_b32 v46, v46, v44, v45
v_xor_b32 v44, s76, v165
v_xor_b32 v45, s77, v167
v_or3_b32 v46, v46, v44, v45
v_xor_b32 v44, s76, v169
v_xor_b32 v45, s77, v171
v_or3_b32 v46, v46, v44, v45
v_xor_b32 v44, s76, v173
v_xor_b32 v45, s77, v175
v_or3_b32 v46, v46, v44, v45
s_waitcnt vmcnt(0)
v_xor_b32 v44, s76, v177
v_xor_b32 v45, s77, v179
v_or3_b32 v46, v46, v44, v45
v_xor_b32 v44, s76, v181
v_xor_b32 v45, s77, v183
v_or3_b32 v46, v46, v44, v45
v_xor_b32 v44, s76, v185
v_xor_b32 v45, s77, v187
v_or3_b32 v46, v46, v44, v45
v_xor_b32 v44, s76, v189
v_xor_b32 v45, s77, v191
v_or3_b32 v46, v46, v44, v45
v_cmp_ne_u32 vcc, 0, v46
s_cbranch_vccnz L_poll
s_mov_b64 exec, -1
v_add_f32 v40, v128, v144
v_add_f32 v41, v130, v146
v_add_f32 v42, v132, v148
v_add_f32 v43, v134, v150
v_add_f32 v44, v136, v152
v_add_f32 v45, v138, v154
v_add_f32 v46, v140, v156
v_add_f32 v47, v142, v158
v_add_f32 v40, v40, v160
v_add_f32 v41, v41, v162
v_add_f32 v42, v42, v164
v_add_f32 v43, v43, v166
v_add_f32 v44, v44, v168
v_add_f32 v45, v45, v170
v_add_f32 v46, v46, v172
v_add_f32 v47, v47, v174
v_add_f32 v40, v40, v176
v_add_f32 v41, v41, v178
v_add_f32 v42, v42, v180
v_add_f32 v43, v43, v182
v_add_f32 v44, v44, v184
v_add_f32 v45, v45, v186
v_add_f32 v46, v46, v188
v_add_f32 v47, v47, v190
s_nop 1
v_permlane32_swap_b32 v40, v44
v_permlane32_swap_b32 v41, v45
v_permlane32_swap_b32 v42, v46
v_permlane32_swap_b32 v43, v47
s_nop 1
v_add_f32 v40, v40, v44
v_add_f32 v41, v41, v45
v_add_f32 v42, v42, v46
v_add_f32 v43, v43, v47
s_nop 1
v_permlane16_swap_b32 v40, v41
v_permlane16_swap_b32 v42, v43
s_nop 1
v_add_f32 v40, v40, v41
v_add_f32 v42, v42, v43
s_nop 1
v_add_f32_dpp v44, v40, v40 row_ror:8 row_mask:0xf bank_mask:0x3
v_add_f32_dpp v44, v42, v42 row_ror:8 row_mask:0xf bank_mask:0xc
L_final:
v_mov_b32 v45, v44
s_nop 1
v_permlane32_swap_b32 v44, v45
s_nop 1
v_cvt_pk_bf16_f32 v44, v44, v44
v_lshlrev_b32 v44, 16, v44
v_cvt_pk_bf16_f32 v45, v45, v45
v_lshlrev_b32 v45, 16, v45
v_lshlrev_b32 v64, 16, v64
v_lshlrev_b32 v65, 16, v65
v_add_f32 v44, v64, v44
v_add_f32 v45, v45, v65
v_cvt_pk_bf16_f32 v44, v44, v44
v_lshlrev_b32 v44, 16, v44
v_cvt_pk_bf16_f32 v45, v45, v45
v_lshlrev_b32 v45, 16, v45
v_add_f32 v44, v44, v45
v_cvt_pk_bf16_f32 v44, v44, v44
s_mov_b32 s40, s24
s_and_b32 s41, s25, 0xffff
s_mov_b32 s42, 8192
s_mov_b32 s43, 0x20000
s_lshl_b32 s51, s31, 10
s_mov_b32 exec_hi, 0
buffer_store_short v44, v70, s[40:43], s51 offen
L_end:
s_endpgm
.section .rodata,"a"
.p2align 6
.amdhsa_kernel parallel_sum__gqa_block_cached__dense_activation_squared_relu__decode_kernel
  .amdhsa_next_free_vgpr 256
  .amdhsa_next_free_sgpr 102
  .amdhsa_accum_offset 256
  .amdhsa_group_segment_fixed_size 0
  .amdhsa_kernarg_size 104
  .amdhsa_user_sgpr_count 2
  .amdhsa_user_sgpr_kernarg_segment_ptr 1
  .amdhsa_system_sgpr_workgroup_id_x 1
  .amdhsa_float_denorm_mode_32 3
.end_amdhsa_kernel
```
